```python
import torch

def _softmax(x, axis=-1):
    return torch.softmax(x, dim=axis)
def _gelu(x):
    return torch.nn.functional.gelu(x, approximate="tanh")
def _silu(x):
    return torch.nn.functional.silu(x)
def _sigmoid(x):
    return torch.sigmoid(x)
def _layernorm(x, axis=-1, eps=1e-5):
    m = x.mean(dim=axis, keepdim=True)
    v = x.var(dim=axis, keepdim=True, unbiased=False)
    return (x - m) / torch.sqrt(v + eps)
def _scatter_add(tgt, idx, src, axis=0):
    return tgt.clone().index_add_(axis, idx, src)
def _segment_sum(src, seg, n):
    out = torch.zeros((n,) + src.shape[1:], dtype=src.dtype)
    return out.index_add_(0, seg, src)
def _pad(x, pw):
    flat = tuple(v for pair in reversed(pw) for v in pair)
    return torch.nn.functional.pad(x, flat)

kernel_name = 'gated_mix__sliding_block_cached__dense_activation_gelu__decode'

def setup_inputs():

    _w = (lambda a: (lambda t: t.to(torch.bfloat16) if t.is_floating_point() else t)(torch.as_tensor(a)))
    def _A_setup():
        B, Sq, D = 1, 1, 512
        Hq, Hkv, Sk, Dh = 32, 8, 65536, 128
        assert Hq % Hkv == 0, (Hq, Hkv)
        return {
            "x": _w((lambda *s: torch.randn(*s, dtype=torch.bfloat16) * 0.05)(B, Sq, D)),
            "k_cache": _w((lambda *s: torch.randn(*s, dtype=torch.bfloat16) * 3.2)(B, Hkv, Sk, Dh)),
            "v_cache": _w((lambda *s: torch.randn(*s, dtype=torch.bfloat16) * 0.4)(B, Hkv, Sk, Dh)),
            "wq": _w((lambda *s: torch.randn(*s, dtype=torch.bfloat16) * 3.2)(D, Hq * Dh) * (D ** -0.5)),
            "wo": _w((lambda *s: torch.randn(*s, dtype=torch.bfloat16) * 0.4)(Hq * Dh, D) * ((Hq * Dh) ** -0.5)),
        }
    _A_in = _A_setup()

    def _B_setup():
        B, S, D, F = 1, 1, 512, 1792
        return {
            "x": _w((lambda *s: torch.randn(*s, dtype=torch.bfloat16) * 0.05)(B, S, D)),
            "w1": _w((lambda *s: torch.randn(*s, dtype=torch.bfloat16) * 0.2)(D, F) * (D ** -0.5)),
            "b1": _w((lambda *s: torch.randn(*s, dtype=torch.bfloat16) * 0.2)(F) * 0.01),
            "w2": _w((lambda *s: torch.randn(*s, dtype=torch.bfloat16) * 0.2)(F, D) * (F ** -0.5)),
            "b2": _w((lambda *s: torch.randn(*s, dtype=torch.bfloat16) * 0.05)(D) * 0.01),
        }
    _B_in = _B_setup()

    return {
        "A_x": _A_in["x"],
        "A_k_cache": _A_in["k_cache"],
        "A_v_cache": _A_in["v_cache"],
        "A_wq": _A_in["wq"],
        "A_wo": _A_in["wo"],
        "B_x": _B_in["x"],
        "B_w1": _B_in["w1"],
        "B_b1": _B_in["b1"],
        "B_w2": _B_in["w2"],
        "B_b2": _B_in["b2"],
        "gate_w": _w((lambda *s: torch.randn(*s, dtype=torch.bfloat16) * 0.1)(512) * 16.0),
    }

def reference(A_x, A_k_cache, A_v_cache, A_wq, A_wo, B_x, B_w1, B_b1, B_w2, B_b2, gate_w):
    def _A_ref(x, k_cache, v_cache, wq, wo):
        B, Sq, D = x.shape
        Hq, Dh = 32, 128
        Hkv, Sk = k_cache.shape[1], k_cache.shape[2]
        W = min(4096, max(256, Sk // 4))
        rep = Hq // Hkv
        q = (lambda x, *d: x.permute(*d))((x @ wq).reshape(B, Sq, Hq, Dh), 0, 2, 1, 3)
        k = (lambda x, n, axis: torch.repeat_interleave(x, n, dim=axis))(k_cache[:, :, Sk - W:, :], rep, axis=1)
        v = (lambda x, n, axis: torch.repeat_interleave(x, n, dim=axis))(v_cache[:, :, Sk - W:, :], rep, axis=1)
        scores = torch.einsum("bhqd,bhkd->bhqk", q, k) * (Dh ** -0.5)
        p = _softmax(scores, axis=-1)
        o = torch.einsum("bhqk,bhkd->bhqd", p, v)
        return (lambda x, *d: x.permute(*d))(o, 0, 2, 1, 3).reshape(B, Sq, Hq * Dh) @ wo

    def _B_ref(x, w1, b1, w2, b2):
        h = torch.einsum("bsd,df->bsf", x, w1) + b1
        h = _gelu(h)
        return torch.einsum("bsf,fd->bsd", h, w2) + b2

    x = A_x
    g = _sigmoid((x * gate_w).sum(-1, keepdims=True))
    a = _A_ref(x, A_k_cache, A_v_cache, A_wq, A_wo)
    b = _B_ref(x, B_w1, B_b1, B_w2, B_b2)
    return g * a + (1 - g) * b
```

```asm
; @launch grid=(256,1,1) block=(256,1,1) lds=2560
.amdgcn_target "amdgcn-amd-amdhsa--gfx950"
.text
.globl gated_mix__sliding_block_cached__dense_activation_gelu__decode_kernel
.p2align 8
.type gated_mix__sliding_block_cached__dense_activation_gelu__decode_kernel,@function
gated_mix__sliding_block_cached__dense_activation_gelu__decode_kernel:
    s_load_dwordx16 s[4:19], s[0:1], 0
    s_load_dwordx4 s[28:31], s[0:1], 96
    s_load_dwordx8 s[20:27], s[0:1], 64
    v_lshrrev_b32 v1, 6, v0
    s_cmp_ge_u32 s2, 256
    s_cbranch_scc1 L_exit
    v_readfirstlane_b32 s3, v1
    v_and_b32 v0, 63, v0
    s_and_b32 s32, s2, 7
    s_lshr_b32 s33, s2, 3
    v_mov_b32 v11, 0
    s_cmp_eq_u32 s3, 0
    s_cbranch_scc1 L_w0
    s_barrier
    s_cmp_eq_u32 s3, 1
    s_cbranch_scc1 L_wa
    s_getpc_b64 s[36:37]
L_pc:
    s_sub_u32 s36, s36, L_pc-gated_mix__sliding_block_cached__dense_activation_gelu__decode_kernel
    s_subb_u32 s37, s37, 0
    s_lshl_b32 s38, s33, 1
    s_add_u32 s38, s38, s3
    s_lshl_b32 s38, s38, 8
    s_min_u32 s38, s38, L_exit-gated_mix__sliding_block_cached__dense_activation_gelu__decode_kernel-256
    v_lshl_add_u32 v21, v0, 2, s38
    global_load_dword v30, v21, s[36:37]
    s_branch L_s2
L_w0:
    v_lshlrev_b32 v14, 2, v0
    ds_write_b32 v14, v11 offset:1104
    v_and_b32 v2, 7, v0
    v_lshrrev_b32 v3, 3, v0
    s_lshr_b32 s35, s33, 3
    s_and_b32 s36, s33, 7
    s_lshl_b32 s37, s35, 10
    s_add_u32 s37, s37, s32
    s_lshl_b32 s37, s37, 3
    s_add_u32 s37, s37, s36
    s_lshl_b32 s37, s37, 7
    v_lshlrev_b32 v4, 17, v3
    v_lshl_add_u32 v4, v2, 4, v4
    v_add_u32 v16, s37, v4
    s_movk_i32 s38, 0x2000
    v_add_u32 v17, s38, v16
    v_add_u32 v18, s38, v17
    v_add_u32 v19, s38, v18
    v_add_u32 v20, s38, v19
    v_add_u32 v21, s38, v20
    v_add_u32 v22, s38, v21
    v_add_u32 v23, s38, v22
    v_add_u32 v24, s38, v23
    v_add_u32 v25, s38, v24
    v_add_u32 v26, s38, v25
    v_add_u32 v27, s38, v26
    v_add_u32 v28, s38, v27
    v_add_u32 v29, s38, v28
    v_add_u32 v30, s38, v29
    v_add_u32 v31, s38, v30
    s_lshl_b32 s37, s35, 8
    v_lshl_add_u32 v5, v3, 5, s37
    s_setprio 3
    s_waitcnt lgkmcnt(0)
    s_barrier
    global_load_dwordx4 v[32:35], v5, s[4:5]
    global_load_dwordx4 v[36:39], v5, s[4:5] offset:16
    global_load_dwordx4 v[64:67], v16, s[10:11] nt
    global_load_dwordx4 v[68:71], v17, s[10:11] nt
    global_load_dwordx4 v[72:75], v18, s[10:11] nt
    global_load_dwordx4 v[76:79], v19, s[10:11] nt
    global_load_dwordx4 v[80:83], v20, s[10:11] nt
    global_load_dwordx4 v[84:87], v21, s[10:11] nt
    global_load_dwordx4 v[88:91], v22, s[10:11] nt
    global_load_dwordx4 v[92:95], v23, s[10:11] nt
    global_load_dwordx4 v[96:99], v24, s[10:11] nt
    global_load_dwordx4 v[100:103], v25, s[10:11] nt
    global_load_dwordx4 v[104:107], v26, s[10:11] nt
    global_load_dwordx4 v[108:111], v27, s[10:11] nt
    global_load_dwordx4 v[112:115], v28, s[10:11] nt
    global_load_dwordx4 v[116:119], v29, s[10:11] nt
    global_load_dwordx4 v[120:123], v30, s[10:11] nt
    global_load_dwordx4 v[124:127], v31, s[10:11] nt
    s_lshl_b32 s37, s32, 8
    s_add_u32 s37, s37, s33
    s_lshl_b32 s37, s37, 8
    s_add_u32 s37, s37, 0x40000
    v_lshlrev_b32 v6, 4, v2
    v_lshl_add_u32 v7, v3, 13, v6
    v_add_u32 v7, s37, v7
    s_lshl_b32 s37, s32, 7
    s_add_u32 s37, s37, s33
    s_lshl_b32 s37, s37, 4
    s_add_u32 s37, s37, 0x30000
    v_lshl_add_u32 v6, v0, 9, s37
    v_mov_b32 v56, 0
    v_mov_b32 v57, 0
    v_mov_b32 v58, 0
    v_mov_b32 v59, 0
    global_store_dwordx4 v7, v[56:59], s[30:31] offset:0
    global_store_dwordx4 v7, v[56:59], s[30:31] offset:128
    s_mov_b64 exec, 0xf
    global_store_dwordx4 v6, v[56:59], s[30:31] offset:0
    s_mov_b64 exec, -1
    global_load_dword v40, v11, s[30:31] offset:0
    s_lshl_b32 s39, s35, 3
    s_add_u32 s39, s39, s32
    s_cmp_lt_u32 s39, 28
    s_cselect_b32 s52, 1, 0
    s_cselect_b64 s[50:51], -1, 1
    s_min_u32 s39, s39, 27
    s_lshl_b32 s37, s36, 7
    v_lshl_add_u32 v196, v3, 4, s37
    s_mul_i32 s37, s36, 229376
    s_lshl_b32 s38, s39, 7
    s_add_u32 s37, s37, s38
    s_mul_i32 s37, s37, s52
    v_mul_u32_u24 v192, 28672, v3
    v_lshl_add_u32 v192, v2, 4, v192
    v_add_u32 v192, s37, v192
    s_movk_i32 s38, 7168
    v_add_u32 v193, s38, v192
    v_add_u32 v194, s38, v193
    v_add_u32 v195, s38, v194
    s_mov_b64 exec, s[50:51]
    global_load_dwordx4 v[188:191], v196, s[4:5]
    global_load_dwordx4 v[128:131], v192, s[16:17] offset:0 nt
    global_load_dwordx4 v[132:135], v192, s[16:17] offset:3584 nt
    global_load_dwordx4 v[136:139], v193, s[16:17] offset:0 nt
    global_load_dwordx4 v[140:143], v193, s[16:17] offset:3584 nt
    global_load_dwordx4 v[144:147], v194, s[16:17] offset:0 nt
    global_load_dwordx4 v[148:151], v194, s[16:17] offset:3584 nt
    global_load_dwordx4 v[152:155], v195, s[16:17] offset:0 nt
    global_load_dwordx4 v[156:159], v195, s[16:17] offset:3584 nt
    v_mov_b32 v12, 1
    s_mov_b64 exec, 1
    ds_write_b32 v11, v12 offset:1152
    s_mov_b64 exec, -1
    s_branch L_w0q
L_wa:
    s_lshl_b32 s49, s32, 12
    s_add_u32 s49, s49, s33
    s_lshl_b32 s49, s49, 12
    s_add_u32 s49, s49, 0xf00000
    v_and_b32 v8, 15, v0
    v_lshrrev_b32 v9, 4, v0
    v_lshlrev_b32 v4, 8, v8
    v_lshl_add_u32 v4, v9, 4, v4
    v_add_u32 v176, s49, v4
    s_mov_b32 s38, 0x20000
    v_add_u32 v177, s38, v176
    v_add_u32 v178, s38, v177
    v_add_u32 v179, s38, v178
    v_add_u32 v180, s38, v179
    v_add_u32 v181, s38, v180
    v_add_u32 v182, s38, v181
    v_add_u32 v183, s38, v182
    s_setprio 2
    s_mov_b32 s48, 0
L_sp_1:
    ds_read_b32 v13, v11 offset:1152
    s_waitcnt lgkmcnt(0)
    v_readfirstlane_b32 s34, v13
    s_nop 0
    s_cmp_ge_u32 s34, 1
    s_cbranch_scc1 L_spd_2
    s_add_u32 s48, s48, 1
    s_cmp_lt_u32 s48, 400000
    s_cbranch_scc1 L_sp_1
L_spd_2:
    global_load_dwordx4 a[0:3], v176, s[6:7] offset:0 nt
    global_load_dwordx4 a[4:7], v176, s[6:7] offset:64 nt
    global_load_dwordx4 a[8:11], v176, s[6:7] offset:128 nt
    global_load_dwordx4 a[12:15], v176, s[6:7] offset:192 nt
    global_load_dwordx4 a[16:19], v177, s[6:7] offset:0 nt
    global_load_dwordx4 a[20:23], v177, s[6:7] offset:64 nt
    global_load_dwordx4 a[24:27], v177, s[6:7] offset:128 nt
    global_load_dwordx4 a[28:31], v177, s[6:7] offset:192 nt
    global_load_dwordx4 a[32:35], v178, s[6:7] offset:0 nt
    global_load_dwordx4 a[36:39], v178, s[6:7] offset:64 nt
    s_branch L_wa2
L_w0q:
    s_mov_b32 s46, 0x05040100
    s_mov_b32 s47, 0x07060302
    v_mov_b32 v10, 0xffffff00
    v_mov_b32 v12, 1
    s_mov_b32 s96, 0xff
    s_mov_b32 s97, 0xff
    v_lshrrev_b32 v197, 5, v0
    v_lshlrev_b32 v197, 4, v197
    v_lshl_add_u32 v197, v2, 5, v197
    s_lshl_b32 s37, s32, 13
    s_lshl_b32 s38, s35, 11
    s_add_u32 s37, s37, s38
    s_lshl_b32 s38, s36, 8
    s_add_u32 s37, s37, s38
    s_add_u32 s37, s37, 0x10000
    v_add_u32 v198, s37, v197
    s_lshl_b32 s37, s39, 11
    s_add_u32 s37, s37, s38
    s_add_u32 s37, s37, 0x20000
    v_add_u32 v199, s37, v197
    v_mov_b32 v56, 0
    v_mov_b32 v57, 0
    v_mov_b32 v58, 0
    v_mov_b32 v59, 0
    v_mov_b32 v60, 0
    v_mov_b32 v61, 0
    v_mov_b32 v62, 0
    v_mov_b32 v63, 0
    v_mov_b32 v13, 0xfffff800
    s_getreg_b32 s55, hwreg(HW_REG_XCC_ID)
    s_and_b32 s55, s55, 7
    s_lshl_b32 s55, s55, 8
    s_waitcnt vmcnt(27)
    v_perm_b32 v160, v68, v64, s46
    v_perm_b32 v161, v68, v64, s47
    v_perm_b32 v162, v69, v65, s46
    v_perm_b32 v163, v69, v65, s47
    v_perm_b32 v164, v70, v66, s46
    v_perm_b32 v165, v70, v66, s47
    v_perm_b32 v166, v71, v67, s46
    v_perm_b32 v167, v71, v67, s47
    v_dot2c_f32_bf16 v56, v160, v32
    v_dot2c_f32_bf16 v57, v161, v32
    v_dot2c_f32_bf16 v58, v162, v32
    v_dot2c_f32_bf16 v59, v163, v32
    v_dot2c_f32_bf16 v60, v164, v32
    v_dot2c_f32_bf16 v61, v165, v32
    v_dot2c_f32_bf16 v62, v166, v32
    v_dot2c_f32_bf16 v63, v167, v32
    s_waitcnt vmcnt(25)
    v_perm_b32 v160, v76, v72, s46
    v_perm_b32 v161, v76, v72, s47
    v_perm_b32 v162, v77, v73, s46
    v_perm_b32 v163, v77, v73, s47
    v_perm_b32 v164, v78, v74, s46
    v_perm_b32 v165, v78, v74, s47
    v_perm_b32 v166, v79, v75, s46
    v_perm_b32 v167, v79, v75, s47
    v_dot2c_f32_bf16 v56, v160, v33
    v_dot2c_f32_bf16 v57, v161, v33
    v_dot2c_f32_bf16 v58, v162, v33
    v_dot2c_f32_bf16 v59, v163, v33
    v_dot2c_f32_bf16 v60, v164, v33
    v_dot2c_f32_bf16 v61, v165, v33
    v_dot2c_f32_bf16 v62, v166, v33
    v_dot2c_f32_bf16 v63, v167, v33
    s_waitcnt vmcnt(23)
    v_perm_b32 v160, v84, v80, s46
    v_perm_b32 v161, v84, v80, s47
    v_perm_b32 v162, v85, v81, s46
    v_perm_b32 v163, v85, v81, s47
    v_perm_b32 v164, v86, v82, s46
    v_perm_b32 v165, v86, v82, s47
    v_perm_b32 v166, v87, v83, s46
    v_perm_b32 v167, v87, v83, s47
    v_dot2c_f32_bf16 v56, v160, v34
    v_dot2c_f32_bf16 v57, v161, v34
    v_dot2c_f32_bf16 v58, v162, v34
    v_dot2c_f32_bf16 v59, v163, v34
    v_dot2c_f32_bf16 v60, v164, v34
    v_dot2c_f32_bf16 v61, v165, v34
    v_dot2c_f32_bf16 v62, v166, v34
    v_dot2c_f32_bf16 v63, v167, v34
    s_waitcnt vmcnt(21)
    v_perm_b32 v160, v92, v88, s46
    v_perm_b32 v161, v92, v88, s47
    v_perm_b32 v162, v93, v89, s46
    v_perm_b32 v163, v93, v89, s47
    v_perm_b32 v164, v94, v90, s46
    v_perm_b32 v165, v94, v90, s47
    v_perm_b32 v166, v95, v91, s46
    v_perm_b32 v167, v95, v91, s47
    v_dot2c_f32_bf16 v56, v160, v35
    v_dot2c_f32_bf16 v57, v161, v35
    v_dot2c_f32_bf16 v58, v162, v35
    v_dot2c_f32_bf16 v59, v163, v35
    v_dot2c_f32_bf16 v60, v164, v35
    v_dot2c_f32_bf16 v61, v165, v35
    v_dot2c_f32_bf16 v62, v166, v35
    v_dot2c_f32_bf16 v63, v167, v35
    s_waitcnt vmcnt(19)
    v_perm_b32 v160, v100, v96, s46
    v_perm_b32 v161, v100, v96, s47
    v_perm_b32 v162, v101, v97, s46
    v_perm_b32 v163, v101, v97, s47
    v_perm_b32 v164, v102, v98, s46
    v_perm_b32 v165, v102, v98, s47
    v_perm_b32 v166, v103, v99, s46
    v_perm_b32 v167, v103, v99, s47
    v_dot2c_f32_bf16 v56, v160, v36
    v_dot2c_f32_bf16 v57, v161, v36
    v_dot2c_f32_bf16 v58, v162, v36
    v_dot2c_f32_bf16 v59, v163, v36
    v_dot2c_f32_bf16 v60, v164, v36
    v_dot2c_f32_bf16 v61, v165, v36
    v_dot2c_f32_bf16 v62, v166, v36
    v_dot2c_f32_bf16 v63, v167, v36
    s_waitcnt vmcnt(17)
    v_perm_b32 v160, v108, v104, s46
    v_perm_b32 v161, v108, v104, s47
    v_perm_b32 v162, v109, v105, s46
    v_perm_b32 v163, v109, v105, s47
    v_perm_b32 v164, v110, v106, s46
    v_perm_b32 v165, v110, v106, s47
    v_perm_b32 v166, v111, v107, s46
    v_perm_b32 v167, v111, v107, s47
    v_dot2c_f32_bf16 v56, v160, v37
    v_dot2c_f32_bf16 v57, v161, v37
    v_dot2c_f32_bf16 v58, v162, v37
    v_dot2c_f32_bf16 v59, v163, v37
    v_dot2c_f32_bf16 v60, v164, v37
    v_dot2c_f32_bf16 v61, v165, v37
    v_dot2c_f32_bf16 v62, v166, v37
    v_dot2c_f32_bf16 v63, v167, v37
    s_waitcnt vmcnt(15)
    v_perm_b32 v160, v116, v112, s46
    v_perm_b32 v161, v116, v112, s47
    v_perm_b32 v162, v117, v113, s46
    v_perm_b32 v163, v117, v113, s47
    v_perm_b32 v164, v118, v114, s46
    v_perm_b32 v165, v118, v114, s47
    v_perm_b32 v166, v119, v115, s46
    v_perm_b32 v167, v119, v115, s47
    v_dot2c_f32_bf16 v56, v160, v38
    v_dot2c_f32_bf16 v57, v161, v38
    v_dot2c_f32_bf16 v58, v162, v38
    v_dot2c_f32_bf16 v59, v163, v38
    v_dot2c_f32_bf16 v60, v164, v38
    v_dot2c_f32_bf16 v61, v165, v38
    v_dot2c_f32_bf16 v62, v166, v38
    v_dot2c_f32_bf16 v63, v167, v38
    s_waitcnt vmcnt(13)
    v_perm_b32 v160, v124, v120, s46
    v_perm_b32 v161, v124, v120, s47
    v_perm_b32 v162, v125, v121, s46
    v_perm_b32 v163, v125, v121, s47
    v_perm_b32 v164, v126, v122, s46
    v_perm_b32 v165, v126, v122, s47
    v_perm_b32 v166, v127, v123, s46
    v_perm_b32 v167, v127, v123, s47
    v_dot2c_f32_bf16 v56, v160, v39
    v_dot2c_f32_bf16 v57, v161, v39
    v_dot2c_f32_bf16 v58, v162, v39
    v_dot2c_f32_bf16 v59, v163, v39
    v_dot2c_f32_bf16 v60, v164, v39
    v_dot2c_f32_bf16 v61, v165, v39
    v_dot2c_f32_bf16 v62, v166, v39
    v_dot2c_f32_bf16 v63, v167, v39
    s_waitcnt vmcnt(9)
    v_readfirstlane_b32 s40, v40
    s_nop 0
    s_bfe_u32 s41, s40, 0x80000
    s_add_u32 s41, s41, 1
    s_lshr_b32 s34, s41, 8
    s_and_b32 s41, s41, 0xff
    s_or_b32 s41, s41, s34
    s_bfe_u32 s42, s40, 0x80008
    s_add_u32 s42, s42, 1
    s_lshr_b32 s34, s42, 8
    s_and_b32 s42, s42, 0xff
    s_or_b32 s42, s42, s34
    s_bfe_u32 s43, s40, 0x80010
    s_add_u32 s43, s43, 1
    s_lshr_b32 s34, s43, 8
    s_and_b32 s43, s43, 0xff
    s_or_b32 s43, s43, s34
    s_bfe_u32 s44, s40, 0x80018
    s_add_u32 s44, s44, 1
    s_lshr_b32 s34, s44, 8
    s_and_b32 s44, s44, 0xff
    s_or_b32 s44, s44, s34
    s_or_b32 s55, s55, s41
    v_permlane32_swap_b32 v56, v60
    v_permlane32_swap_b32 v57, v61
    v_permlane32_swap_b32 v58, v62
    v_permlane32_swap_b32 v59, v63
    v_add_f32 v56, v56, v60
    v_add_f32 v57, v57, v61
    v_add_f32 v58, v58, v62
    v_add_f32 v59, v59, v63
    v_add_f32_dpp v56, v56, v56 row_ror:8 row_mask:0xf bank_mask:0xf
    v_add_f32_dpp v57, v57, v57 row_ror:8 row_mask:0xf bank_mask:0xf
    v_add_f32_dpp v58, v58, v58 row_ror:8 row_mask:0xf bank_mask:0xf
    v_add_f32_dpp v59, v59, v59 row_ror:8 row_mask:0xf bank_mask:0xf
    v_mov_b32 v160, v56
    v_mov_b32 v161, v57
    v_mov_b32 v162, v58
    v_mov_b32 v163, v59
    v_permlane16_swap_b32 v56, v160
    v_permlane16_swap_b32 v57, v161
    v_permlane16_swap_b32 v58, v162
    v_permlane16_swap_b32 v59, v163
    v_add_f32 v56, v56, v160
    v_add_f32 v57, v57, v161
    v_add_f32 v58, v58, v162
    v_add_f32 v59, v59, v163
    v_and_or_b32 v164, v56, v13, s55
    v_and_or_b32 v165, v57, v10, s42
    v_and_or_b32 v166, v58, v10, s43
    v_and_or_b32 v167, v59, v10, s44
    s_mov_b64 exec, s[96:97]
    global_store_dwordx4 v198, v[164:167], s[30:31] offset:0
    s_mov_b64 exec, -1
L_noqpub:
    s_mov_b64 exec, 1
    v_mov_b32 v168, s41
    v_mov_b32 v169, s42
    v_mov_b32 v170, s43
    v_mov_b32 v171, s44
    ds_write_b128 v11, v[168:171] offset:1168
    s_mov_b64 exec, -1
    v_mov_b32 v56, 0
    v_mov_b32 v57, 0
    v_mov_b32 v58, 0
    v_mov_b32 v59, 0
    v_mov_b32 v60, 0
    v_mov_b32 v61, 0
    v_mov_b32 v62, 0
    v_mov_b32 v63, 0
    s_waitcnt vmcnt(7)
    v_perm_b32 v168, v132, v128, s46
    v_perm_b32 v169, v132, v128, s47
    v_perm_b32 v170, v133, v129, s46
    v_perm_b32 v171, v133, v129, s47
    v_perm_b32 v172, v134, v130, s46
    v_perm_b32 v173, v134, v130, s47
    v_perm_b32 v174, v135, v131, s46
    v_perm_b32 v175, v135, v131, s47
    v_dot2c_f32_bf16 v56, v168, v188
    v_dot2c_f32_bf16 v57, v169, v188
    v_dot2c_f32_bf16 v58, v170, v188
    v_dot2c_f32_bf16 v59, v171, v188
    v_dot2c_f32_bf16 v60, v172, v188
    v_dot2c_f32_bf16 v61, v173, v188
    v_dot2c_f32_bf16 v62, v174, v188
    v_dot2c_f32_bf16 v63, v175, v188
    s_waitcnt vmcnt(5)
    v_perm_b32 v168, v140, v136, s46
    v_perm_b32 v169, v140, v136, s47
    v_perm_b32 v170, v141, v137, s46
    v_perm_b32 v171, v141, v137, s47
    v_perm_b32 v172, v142, v138, s46
    v_perm_b32 v173, v142, v138, s47
    v_perm_b32 v174, v143, v139, s46
    v_perm_b32 v175, v143, v139, s47
    v_dot2c_f32_bf16 v56, v168, v189
    v_dot2c_f32_bf16 v57, v169, v189
    v_dot2c_f32_bf16 v58, v170, v189
    v_dot2c_f32_bf16 v59, v171, v189
    v_dot2c_f32_bf16 v60, v172, v189
    v_dot2c_f32_bf16 v61, v173, v189
    v_dot2c_f32_bf16 v62, v174, v189
    v_dot2c_f32_bf16 v63, v175, v189
    s_waitcnt vmcnt(3)
    v_perm_b32 v168, v148, v144, s46
    v_perm_b32 v169, v148, v144, s47
    v_perm_b32 v170, v149, v145, s46
    v_perm_b32 v171, v149, v145, s47
    v_perm_b32 v172, v150, v146, s46
    v_perm_b32 v173, v150, v146, s47
    v_perm_b32 v174, v151, v147, s46
    v_perm_b32 v175, v151, v147, s47
    v_dot2c_f32_bf16 v56, v168, v190
    v_dot2c_f32_bf16 v57, v169, v190
    v_dot2c_f32_bf16 v58, v170, v190
    v_dot2c_f32_bf16 v59, v171, v190
    v_dot2c_f32_bf16 v60, v172, v190
    v_dot2c_f32_bf16 v61, v173, v190
    v_dot2c_f32_bf16 v62, v174, v190
    v_dot2c_f32_bf16 v63, v175, v190
    s_waitcnt vmcnt(1)
    v_perm_b32 v168, v156, v152, s46
    v_perm_b32 v169, v156, v152, s47
    v_perm_b32 v170, v157, v153, s46
    v_perm_b32 v171, v157, v153, s47
    v_perm_b32 v172, v158, v154, s46
    v_perm_b32 v173, v158, v154, s47
    v_perm_b32 v174, v159, v155, s46
    v_perm_b32 v175, v159, v155, s47
    v_dot2c_f32_bf16 v56, v168, v191
    v_dot2c_f32_bf16 v57, v169, v191
    v_dot2c_f32_bf16 v58, v170, v191
    v_dot2c_f32_bf16 v59, v171, v191
    v_dot2c_f32_bf16 v60, v172, v191
    v_dot2c_f32_bf16 v61, v173, v191
    v_dot2c_f32_bf16 v62, v174, v191
    v_dot2c_f32_bf16 v63, v175, v191
    v_permlane32_swap_b32 v56, v60
    v_permlane32_swap_b32 v57, v61
    v_permlane32_swap_b32 v58, v62
    v_permlane32_swap_b32 v59, v63
    v_add_f32 v56, v56, v60
    v_add_f32 v57, v57, v61
    v_add_f32 v58, v58, v62
    v_add_f32 v59, v59, v63
    v_add_f32_dpp v56, v56, v56 row_ror:8 row_mask:0xf bank_mask:0xf
    v_add_f32_dpp v57, v57, v57 row_ror:8 row_mask:0xf bank_mask:0xf
    v_add_f32_dpp v58, v58, v58 row_ror:8 row_mask:0xf bank_mask:0xf
    v_add_f32_dpp v59, v59, v59 row_ror:8 row_mask:0xf bank_mask:0xf
    v_mov_b32 v168, v56
    v_mov_b32 v169, v57
    v_mov_b32 v170, v58
    v_mov_b32 v171, v59
    v_permlane16_swap_b32 v56, v168
    v_permlane16_swap_b32 v57, v169
    v_permlane16_swap_b32 v58, v170
    v_permlane16_swap_b32 v59, v171
    v_add_f32 v56, v56, v168
    v_add_f32 v57, v57, v169
    v_add_f32 v58, v58, v170
    v_add_f32 v59, v59, v171
    v_and_or_b32 v28, v56, v10, s41
    v_and_or_b32 v29, v57, v10, s42
    v_and_or_b32 v30, v58, v10, s43
    v_and_or_b32 v31, v59, v10, s44
    s_cmp_eq_u32 s52, 0
    s_cbranch_scc1 L_nohpub
    s_mov_b64 exec, s[96:97]
    global_store_dwordx4 v199, v[28:31], s[30:31] offset:0
    s_mov_b64 exec, -1
L_nohpub:
    s_branch L_w0c
L_wa2:
    v_mov_b32 v2, v8
    v_mov_b32 v3, v9
    s_mov_b32 s35, s49
    s_mov_b32 s46, 0x05040100
    s_mov_b32 s47, 0x07060302
    v_mov_b32 v10, 0xffffff00
    v_mov_b32 v12, 1
    v_lshlrev_b32 v4, 10, v3
    v_lshl_add_u32 v4, v2, 4, v4
    v_add_u32 v184, s35, v4
    v_add_u32 v185, s38, v184
    v_add_u32 v186, s38, v185
    v_add_u32 v187, s38, v186
    v_add_u32 v188, s38, v187
    v_add_u32 v189, s38, v188
    v_add_u32 v190, s38, v189
    v_add_u32 v191, s38, v190
    v_lshrrev_b32 v15, 2, v2
    s_lshl_b32 s36, s32, 11
    s_lshl_b32 s37, s33, 4
    s_add_u32 s37, s37, s36
    s_add_u32 s37, s37, 0x30000
    v_lshl_add_u32 v7, v15, 9, s37
    v_mul_u32_u24 v9, 272, v15
    v_lshl_add_u32 v9, v3, 4, v9
    s_lshl_b32 s36, s32, 16
    s_add_u32 s36, s36, 0x40000
    v_lshrrev_b32 v8, 3, v2
    v_lshl_add_u32 v8, v3, 1, v8
    v_lshlrev_b32 v8, 13, v8
    v_and_b32 v5, 7, v2
    v_lshl_add_u32 v8, v5, 4, v8
    s_lshl_b32 s37, s33, 8
    s_add_u32 s37, s36, s37
    v_add_u32 v8, s37, v8
    s_mov_b32 s49, 0x3e0293ee
    s_mov_b32 s60, s49
    s_mov_b32 s61, s49
    global_load_dwordx4 a[40:43], v178, s[6:7] offset:128 nt
    global_load_dwordx4 a[44:47], v178, s[6:7] offset:192 nt
    global_load_dwordx4 a[48:51], v179, s[6:7] offset:0 nt
    global_load_dwordx4 a[52:55], v179, s[6:7] offset:64 nt
    global_load_dwordx4 a[56:59], v179, s[6:7] offset:128 nt
    s_waitcnt vmcnt(14)
    global_load_dwordx4 a[60:63], v179, s[6:7] offset:192 nt
    s_waitcnt vmcnt(14)
    global_load_dwordx4 a[64:67], v180, s[6:7] offset:0 nt
    s_waitcnt vmcnt(14)
    global_load_dwordx4 a[68:71], v180, s[6:7] offset:64 nt
    s_waitcnt vmcnt(14)
    global_load_dwordx4 a[72:75], v180, s[6:7] offset:128 nt
    s_waitcnt vmcnt(14)
    global_load_dwordx4 a[76:79], v180, s[6:7] offset:192 nt
    s_waitcnt vmcnt(14)
    global_load_dwordx4 a[80:83], v181, s[6:7] offset:0 nt
    s_waitcnt vmcnt(14)
    global_load_dwordx4 a[84:87], v181, s[6:7] offset:64 nt
    s_waitcnt vmcnt(14)
    global_load_dwordx4 a[88:91], v181, s[6:7] offset:128 nt
    s_waitcnt vmcnt(14)
    global_load_dwordx4 a[92:95], v181, s[6:7] offset:192 nt
    s_waitcnt vmcnt(14)
    global_load_dwordx4 a[96:99], v182, s[6:7] offset:0 nt
    s_waitcnt vmcnt(14)
    global_load_dwordx4 a[100:103], v182, s[6:7] offset:64 nt
    s_waitcnt vmcnt(14)
    global_load_dwordx4 a[104:107], v182, s[6:7] offset:128 nt
    s_waitcnt vmcnt(14)
    global_load_dwordx4 a[108:111], v182, s[6:7] offset:192 nt
    s_waitcnt vmcnt(14)
    global_load_dwordx4 a[112:115], v183, s[6:7] offset:0 nt
    s_waitcnt vmcnt(14)
    global_load_dwordx4 a[116:119], v183, s[6:7] offset:64 nt
    s_waitcnt vmcnt(14)
    global_load_dwordx4 a[120:123], v183, s[6:7] offset:128 nt
    s_waitcnt vmcnt(14)
    global_load_dwordx4 a[124:127], v183, s[6:7] offset:192 nt
    s_waitcnt vmcnt(14)
    global_load_dwordx4 v[48:51], v184, s[8:9] offset:0 nt
    s_waitcnt vmcnt(14)
    global_load_dwordx4 v[52:55], v184, s[8:9] offset:256 nt
    s_waitcnt vmcnt(14)
    global_load_dwordx4 v[56:59], v184, s[8:9] offset:512 nt
    s_waitcnt vmcnt(14)
    global_load_dwordx4 v[60:63], v184, s[8:9] offset:768 nt
    s_waitcnt vmcnt(14)
    global_load_dwordx4 v[64:67], v185, s[8:9] offset:0 nt
    s_waitcnt vmcnt(14)
    global_load_dwordx4 v[68:71], v185, s[8:9] offset:256 nt
    s_mov_b64 exec, 1
    ds_write_b32 v11, v12 offset:1140
    s_mov_b64 exec, -1
    s_waitcnt vmcnt(14)
    global_load_dwordx4 v[72:75], v185, s[8:9] offset:512 nt
    s_waitcnt vmcnt(14)
    global_load_dwordx4 v[76:79], v185, s[8:9] offset:768 nt
    s_waitcnt vmcnt(14)
    global_load_dwordx4 v[80:83], v186, s[8:9] offset:0 nt
    s_waitcnt vmcnt(14)
    global_load_dwordx4 v[84:87], v186, s[8:9] offset:256 nt
    s_waitcnt vmcnt(14)
    global_load_dwordx4 v[88:91], v186, s[8:9] offset:512 nt
    s_waitcnt vmcnt(14)
    global_load_dwordx4 v[92:95], v186, s[8:9] offset:768 nt
    s_waitcnt vmcnt(14)
    global_load_dwordx4 v[96:99], v187, s[8:9] offset:0 nt
    s_waitcnt vmcnt(14)
    global_load_dwordx4 v[100:103], v187, s[8:9] offset:256 nt
    global_load_dwordx4 v[104:107], v187, s[8:9] offset:512 nt
    global_load_dwordx4 v[108:111], v187, s[8:9] offset:768 nt
    global_load_dwordx4 v[112:115], v188, s[8:9] offset:0 nt
    global_load_dwordx4 v[116:119], v188, s[8:9] offset:256 nt
    global_load_dwordx4 v[120:123], v188, s[8:9] offset:512 nt
    global_load_dwordx4 v[124:127], v188, s[8:9] offset:768 nt
    global_load_dwordx4 v[128:131], v189, s[8:9] offset:0 nt
    global_load_dwordx4 v[132:135], v189, s[8:9] offset:256 nt
    global_load_dwordx4 v[136:139], v189, s[8:9] offset:512 nt
    global_load_dwordx4 v[140:143], v189, s[8:9] offset:768 nt
    global_load_dwordx4 v[144:147], v190, s[8:9] offset:0 nt
    global_load_dwordx4 v[148:151], v190, s[8:9] offset:256 nt
    global_load_dwordx4 v[152:155], v190, s[8:9] offset:512 nt
    global_load_dwordx4 v[156:159], v190, s[8:9] offset:768 nt
    global_load_dwordx4 v[160:163], v191, s[8:9] offset:0 nt
    global_load_dwordx4 v[164:167], v191, s[8:9] offset:256 nt
    global_load_dwordx4 v[168:171], v191, s[8:9] offset:512 nt
    global_load_dwordx4 v[172:175], v191, s[8:9] offset:768 nt
    s_mov_b64 exec, 1
    ds_write_b32 v11, v12 offset:1116
    s_mov_b64 exec, -1
    s_setprio 3
L_wat:
    s_mov_b32 s48, 0
L_q_3:
    ds_read_b32 v13, v11 offset:1104
    ds_read_b128 v[240:243], v9 offset:0
    ds_read_b128 v[244:247], v9 offset:64
    ds_read_b128 v[248:251], v9 offset:128
    ds_read_b128 v[252:255], v9 offset:192
    s_add_u32 s48, s48, 1
    s_cmp_lt_u32 s48, 400000
    s_cselect_b32 s35, 1, 0
    s_waitcnt lgkmcnt(0)
    v_readfirstlane_b32 s34, v13
    s_nop 0
    s_cmp_lt_u32 s34, s35
    s_cbranch_scc1 L_q_3
    s_waitcnt vmcnt(32)
    v_mfma_f32_16x16x32_bf16 v[208:211], a[0:3], v[240:243], 0
    v_mfma_f32_16x16x32_bf16 v[212:215], a[16:19], v[240:243], 0
    v_mfma_f32_16x16x32_bf16 v[216:219], a[32:35], v[240:243], 0
    v_mfma_f32_16x16x32_bf16 v[220:223], a[48:51], v[240:243], 0
    v_mfma_f32_16x16x32_bf16 v[224:227], a[64:67], v[240:243], 0
    v_mfma_f32_16x16x32_bf16 v[228:231], a[80:83], v[240:243], 0
    v_mfma_f32_16x16x32_bf16 v[232:235], a[96:99], v[240:243], 0
    v_mfma_f32_16x16x32_bf16 v[236:239], a[112:115], v[240:243], 0
    v_mfma_f32_16x16x32_bf16 v[208:211], a[4:7], v[244:247], v[208:211]
    v_mfma_f32_16x16x32_bf16 v[212:215], a[20:23], v[244:247], v[212:215]
    v_mfma_f32_16x16x32_bf16 v[216:219], a[36:39], v[244:247], v[216:219]
    v_mfma_f32_16x16x32_bf16 v[220:223], a[52:55], v[244:247], v[220:223]
    v_mfma_f32_16x16x32_bf16 v[224:227], a[68:71], v[244:247], v[224:227]
    v_mfma_f32_16x16x32_bf16 v[228:231], a[84:87], v[244:247], v[228:231]
    v_mfma_f32_16x16x32_bf16 v[232:235], a[100:103], v[244:247], v[232:235]
    v_mfma_f32_16x16x32_bf16 v[236:239], a[116:119], v[244:247], v[236:239]
    v_mfma_f32_16x16x32_bf16 v[208:211], a[8:11], v[248:251], v[208:211]
    v_mfma_f32_16x16x32_bf16 v[212:215], a[24:27], v[248:251], v[212:215]
    v_mfma_f32_16x16x32_bf16 v[216:219], a[40:43], v[248:251], v[216:219]
    v_mfma_f32_16x16x32_bf16 v[220:223], a[56:59], v[248:251], v[220:223]
    v_mfma_f32_16x16x32_bf16 v[224:227], a[72:75], v[248:251], v[224:227]
    v_mfma_f32_16x16x32_bf16 v[228:231], a[88:91], v[248:251], v[228:231]
    v_mfma_f32_16x16x32_bf16 v[232:235], a[104:107], v[248:251], v[232:235]
    v_mfma_f32_16x16x32_bf16 v[236:239], a[120:123], v[248:251], v[236:239]
    v_mfma_f32_16x16x32_bf16 v[208:211], a[12:15], v[252:255], v[208:211]
    v_mfma_f32_16x16x32_bf16 v[212:215], a[28:31], v[252:255], v[212:215]
    v_mfma_f32_16x16x32_bf16 v[216:219], a[44:47], v[252:255], v[216:219]
    v_mfma_f32_16x16x32_bf16 v[220:223], a[60:63], v[252:255], v[220:223]
    v_mfma_f32_16x16x32_bf16 v[224:227], a[76:79], v[252:255], v[224:227]
    v_mfma_f32_16x16x32_bf16 v[228:231], a[92:95], v[252:255], v[228:231]
    v_mfma_f32_16x16x32_bf16 v[232:235], a[108:111], v[252:255], v[232:235]
    v_mfma_f32_16x16x32_bf16 v[236:239], a[124:127], v[252:255], v[236:239]
    ds_read_b32 v14, v11 offset:1136
    ds_read_b128 v[180:183], v11 offset:1168
    v_max3_f32 v4, v208, v209, v210
    v_max_f32 v4, v4, v211
    v_max3_f32 v5, v212, v213, v214
    v_max_f32 v5, v5, v215
    v_max3_f32 v4, v4, v216, v217
    v_max3_f32 v4, v4, v218, v219
    v_max3_f32 v5, v5, v220, v221
    v_max3_f32 v5, v5, v222, v223
    v_max3_f32 v4, v4, v224, v225
    v_max3_f32 v4, v4, v226, v227
    v_max3_f32 v5, v5, v228, v229
    v_max3_f32 v5, v5, v230, v231
    v_max3_f32 v4, v4, v232, v233
    v_max3_f32 v4, v4, v234, v235
    v_max3_f32 v5, v5, v236, v237
    v_max3_f32 v5, v5, v238, v239
    v_max_f32 v4, v4, v5
    v_mov_b32 v5, v4
    s_nop 1
    v_permlane16_swap_b32 v4, v5
    v_max_f32 v4, v4, v5
    v_mov_b32 v5, v4
    s_nop 1
    v_permlane32_swap_b32 v4, v5
    v_max_f32 v4, v4, v5
    v_mul_f32 v4, s49, v4
    v_and_b32 v4, v4, v10
    v_fma_f32 v208, v208, s49, -v4
    v_fma_f32 v209, v209, s49, -v4
    v_fma_f32 v210, v210, s49, -v4
    v_fma_f32 v211, v211, s49, -v4
    v_fma_f32 v212, v212, s49, -v4
    v_fma_f32 v213, v213, s49, -v4
    v_fma_f32 v214, v214, s49, -v4
    v_fma_f32 v215, v215, s49, -v4
    v_exp_f32 v208, v208
    v_exp_f32 v209, v209
    v_exp_f32 v210, v210
    v_exp_f32 v211, v211
    v_exp_f32 v212, v212
    v_exp_f32 v213, v213
    v_exp_f32 v214, v214
    v_exp_f32 v215, v215
    v_cvt_pk_bf16_f32 v240, v208, v209
    v_cvt_pk_bf16_f32 v241, v210, v211
    v_cvt_pk_bf16_f32 v242, v212, v213
    v_cvt_pk_bf16_f32 v243, v214, v215
    v_fma_f32 v216, v216, s49, -v4
    v_fma_f32 v217, v217, s49, -v4
    v_fma_f32 v218, v218, s49, -v4
    v_fma_f32 v219, v219, s49, -v4
    v_fma_f32 v220, v220, s49, -v4
    v_fma_f32 v221, v221, s49, -v4
    v_fma_f32 v222, v222, s49, -v4
    v_fma_f32 v223, v223, s49, -v4
    v_exp_f32 v216, v216
    v_exp_f32 v217, v217
    v_exp_f32 v218, v218
    v_exp_f32 v219, v219
    v_exp_f32 v220, v220
    v_exp_f32 v221, v221
    v_exp_f32 v222, v222
    v_exp_f32 v223, v223
    v_cvt_pk_bf16_f32 v244, v216, v217
    v_cvt_pk_bf16_f32 v245, v218, v219
    v_cvt_pk_bf16_f32 v246, v220, v221
    v_cvt_pk_bf16_f32 v247, v222, v223
    v_fma_f32 v224, v224, s49, -v4
    v_fma_f32 v225, v225, s49, -v4
    v_fma_f32 v226, v226, s49, -v4
    v_fma_f32 v227, v227, s49, -v4
    v_fma_f32 v228, v228, s49, -v4
    v_fma_f32 v229, v229, s49, -v4
    v_fma_f32 v230, v230, s49, -v4
    v_fma_f32 v231, v231, s49, -v4
    v_exp_f32 v224, v224
    v_exp_f32 v225, v225
    v_exp_f32 v226, v226
    v_exp_f32 v227, v227
    v_exp_f32 v228, v228
    v_exp_f32 v229, v229
    v_exp_f32 v230, v230
    v_exp_f32 v231, v231
    v_cvt_pk_bf16_f32 v248, v224, v225
    v_cvt_pk_bf16_f32 v249, v226, v227
    v_cvt_pk_bf16_f32 v250, v228, v229
    v_cvt_pk_bf16_f32 v251, v230, v231
    v_fma_f32 v232, v232, s49, -v4
    v_fma_f32 v233, v233, s49, -v4
    v_fma_f32 v234, v234, s49, -v4
    v_fma_f32 v235, v235, s49, -v4
    v_fma_f32 v236, v236, s49, -v4
    v_fma_f32 v237, v237, s49, -v4
    v_fma_f32 v238, v238, s49, -v4
    v_fma_f32 v239, v239, s49, -v4
    v_exp_f32 v232, v232
    v_exp_f32 v233, v233
    v_exp_f32 v234, v234
    v_exp_f32 v235, v235
    v_exp_f32 v236, v236
    v_exp_f32 v237, v237
    v_exp_f32 v238, v238
    v_exp_f32 v239, v239
    v_cvt_pk_bf16_f32 v252, v232, v233
    v_cvt_pk_bf16_f32 v253, v234, v235
    v_cvt_pk_bf16_f32 v254, v236, v237
    v_cvt_pk_bf16_f32 v255, v238, v239
    v_add_f32 v208, v208, v224
    v_add_f32 v209, v209, v225
    v_add_f32 v210, v210, v226
    v_add_f32 v211, v211, v227
    v_add_f32 v212, v212, v228
    v_add_f32 v213, v213, v229
    v_add_f32 v214, v214, v230
    v_add_f32 v215, v215, v231
    v_add_f32 v216, v216, v232
    v_add_f32 v217, v217, v233
    v_add_f32 v218, v218, v234
    v_add_f32 v219, v219, v235
    v_add_f32 v220, v220, v236
    v_add_f32 v221, v221, v237
    v_add_f32 v222, v222, v238
    v_add_f32 v223, v223, v239
    v_add_f32 v208, v208, v216
    v_add_f32 v209, v209, v217
    v_add_f32 v210, v210, v218
    v_add_f32 v211, v211, v219
    v_add_f32 v212, v212, v220
    v_add_f32 v213, v213, v221
    v_add_f32 v214, v214, v222
    v_add_f32 v215, v215, v223
    v_add_f32 v208, v208, v212
    v_add_f32 v209, v209, v213
    v_add_f32 v210, v210, v214
    v_add_f32 v211, v211, v215
    v_add_f32 v208, v208, v210
    v_add_f32 v209, v209, v211
    v_add_f32 v208, v208, v209
    v_mov_b32 v5, v208
    s_nop 1
    v_permlane16_swap_b32 v208, v5
    v_add_f32 v208, v208, v5
    v_mov_b32 v5, v208
    s_nop 1
    v_permlane32_swap_b32 v208, v5
    v_add_f32 v208, v208, v5
    s_waitcnt lgkmcnt(0)
    v_readfirstlane_b32 s41, v180
    v_readfirstlane_b32 s42, v181
    v_readfirstlane_b32 s43, v182
    v_readfirstlane_b32 s44, v183
    v_and_or_b32 v212, v4, v10, s41
    v_and_or_b32 v213, v208, v10, s42
    v_and_or_b32 v214, v4, v10, s43
    v_and_or_b32 v215, v208, v10, s44
    v_readfirstlane_b32 s99, v14
    s_nop 0
    s_cmp_lg_u32 s99, 0
    s_cbranch_scc1 L_mok
    s_mov_b32 s48, 0
L_sp_4:
    ds_read_b32 v13, v11 offset:1136
    s_waitcnt lgkmcnt(0)
    v_readfirstlane_b32 s34, v13
    s_nop 0
    s_cmp_ge_u32 s34, 1
    s_cbranch_scc1 L_spd_5
    s_add_u32 s48, s48, 1
    s_cmp_lt_u32 s48, 400000
    s_cbranch_scc1 L_sp_4
L_spd_5:
    s_mov_b32 s99, s34
L_mok:
    s_mov_b64 exec, 0x1111
    s_cmp_eq_u32 s99, 1
    s_cbranch_scc1 L_stA
    global_store_dwordx4 v7, v[212:215], s[30:31] offset:0 sc1
    s_branch L_stD
L_stA:
    global_store_dwordx4 v7, v[212:215], s[30:31] offset:0
L_stD:
    s_mov_b64 exec, -1
    s_waitcnt vmcnt(25)
    v_perm_b32 v16, v52, v48, s46
    v_perm_b32 v20, v52, v48, s47
    v_perm_b32 v24, v53, v49, s46
    v_perm_b32 v28, v53, v49, s47
    v_perm_b32 v32, v54, v50, s46
    v_perm_b32 v36, v54, v50, s47
    v_perm_b32 v40, v55, v51, s46
    v_perm_b32 v44, v55, v51, s47
    v_perm_b32 v17, v60, v56, s46
    v_perm_b32 v21, v60, v56, s47
    v_perm_b32 v25, v61, v57, s46
    v_perm_b32 v29, v61, v57, s47
    v_perm_b32 v33, v62, v58, s46
    v_perm_b32 v37, v62, v58, s47
    v_perm_b32 v41, v63, v59, s46
    v_perm_b32 v45, v63, v59, s47
    v_perm_b32 v18, v68, v64, s46
    v_perm_b32 v22, v68, v64, s47
    v_perm_b32 v26, v69, v65, s46
    v_perm_b32 v30, v69, v65, s47
    v_perm_b32 v34, v70, v66, s46
    v_perm_b32 v38, v70, v66, s47
    v_perm_b32 v42, v71, v67, s46
    v_perm_b32 v46, v71, v67, s47
    v_perm_b32 v19, v76, v72, s46
    v_perm_b32 v23, v76, v72, s47
    v_perm_b32 v27, v77, v73, s46
    v_perm_b32 v31, v77, v73, s47
    v_perm_b32 v35, v78, v74, s46
    v_perm_b32 v39, v78, v74, s47
    v_perm_b32 v43, v79, v75, s46
    v_perm_b32 v47, v79, v75, s47
    s_waitcnt vmcnt(17)
    v_mfma_f32_16x16x32_bf16 v[176:179], v[240:243], v[16:19], 0
    v_perm_b32 v48, v84, v80, s46
    v_perm_b32 v52, v84, v80, s47
    v_perm_b32 v56, v85, v81, s46
    v_perm_b32 v60, v85, v81, s47
    v_mfma_f32_16x16x32_bf16 v[180:183], v[240:243], v[20:23], 0
    v_perm_b32 v64, v86, v82, s46
    v_perm_b32 v68, v86, v82, s47
    v_perm_b32 v72, v87, v83, s46
    v_perm_b32 v76, v87, v83, s47
    v_mfma_f32_16x16x32_bf16 v[184:187], v[240:243], v[24:27], 0
    v_perm_b32 v49, v92, v88, s46
    v_perm_b32 v53, v92, v88, s47
    v_perm_b32 v57, v93, v89, s46
    v_perm_b32 v61, v93, v89, s47
    v_mfma_f32_16x16x32_bf16 v[188:191], v[240:243], v[28:31], 0
    v_perm_b32 v65, v94, v90, s46
    v_perm_b32 v69, v94, v90, s47
    v_perm_b32 v73, v95, v91, s46
    v_perm_b32 v77, v95, v91, s47
    v_mfma_f32_16x16x32_bf16 v[192:195], v[240:243], v[32:35], 0
    v_perm_b32 v50, v100, v96, s46
    v_perm_b32 v54, v100, v96, s47
    v_perm_b32 v58, v101, v97, s46
    v_perm_b32 v62, v101, v97, s47
    v_mfma_f32_16x16x32_bf16 v[196:199], v[240:243], v[36:39], 0
    v_perm_b32 v66, v102, v98, s46
    v_perm_b32 v70, v102, v98, s47
    v_perm_b32 v74, v103, v99, s46
    v_perm_b32 v78, v103, v99, s47
    v_mfma_f32_16x16x32_bf16 v[200:203], v[240:243], v[40:43], 0
    v_perm_b32 v51, v108, v104, s46
    v_perm_b32 v55, v108, v104, s47
    v_perm_b32 v59, v109, v105, s46
    v_perm_b32 v63, v109, v105, s47
    v_mfma_f32_16x16x32_bf16 v[204:207], v[240:243], v[44:47], 0
    v_perm_b32 v67, v110, v106, s46
    v_perm_b32 v71, v110, v106, s47
    v_perm_b32 v75, v111, v107, s46
    v_perm_b32 v79, v111, v107, s47
    s_waitcnt vmcnt(9)
    v_mfma_f32_16x16x32_bf16 v[176:179], v[244:247], v[48:51], v[176:179]
    v_perm_b32 v80, v116, v112, s46
    v_perm_b32 v84, v116, v112, s47
    v_perm_b32 v88, v117, v113, s46
    v_perm_b32 v92, v117, v113, s47
    v_mfma_f32_16x16x32_bf16 v[180:183], v[244:247], v[52:55], v[180:183]
    v_perm_b32 v96, v118, v114, s46
    v_perm_b32 v100, v118, v114, s47
    v_perm_b32 v104, v119, v115, s46
    v_perm_b32 v108, v119, v115, s47
    v_mfma_f32_16x16x32_bf16 v[184:187], v[244:247], v[56:59], v[184:187]
    v_perm_b32 v81, v124, v120, s46
    v_perm_b32 v85, v124, v120, s47
    v_perm_b32 v89, v125, v121, s46
    v_perm_b32 v93, v125, v121, s47
    v_mfma_f32_16x16x32_bf16 v[188:191], v[244:247], v[60:63], v[188:191]
    v_perm_b32 v97, v126, v122, s46
    v_perm_b32 v101, v126, v122, s47
    v_perm_b32 v105, v127, v123, s46
    v_perm_b32 v109, v127, v123, s47
    v_mfma_f32_16x16x32_bf16 v[192:195], v[244:247], v[64:67], v[192:195]
    v_perm_b32 v82, v132, v128, s46
    v_perm_b32 v86, v132, v128, s47
    v_perm_b32 v90, v133, v129, s46
    v_perm_b32 v94, v133, v129, s47
    v_mfma_f32_16x16x32_bf16 v[196:199], v[244:247], v[68:71], v[196:199]
    v_perm_b32 v98, v134, v130, s46
    v_perm_b32 v102, v134, v130, s47
    v_perm_b32 v106, v135, v131, s46
    v_perm_b32 v110, v135, v131, s47
    v_mfma_f32_16x16x32_bf16 v[200:203], v[244:247], v[72:75], v[200:203]
    v_perm_b32 v83, v140, v136, s46
    v_perm_b32 v87, v140, v136, s47
    v_perm_b32 v91, v141, v137, s46
    v_perm_b32 v95, v141, v137, s47
    v_mfma_f32_16x16x32_bf16 v[204:207], v[244:247], v[76:79], v[204:207]
    v_perm_b32 v99, v142, v138, s46
    v_perm_b32 v103, v142, v138, s47
    v_perm_b32 v107, v143, v139, s46
    v_perm_b32 v111, v143, v139, s47
    s_waitcnt vmcnt(7)
    v_mfma_f32_16x16x32_bf16 v[176:179], v[248:251], v[80:83], v[176:179]
    v_perm_b32 v112, v148, v144, s46
    v_perm_b32 v116, v148, v144, s47
    v_mfma_f32_16x16x32_bf16 v[180:183], v[248:251], v[84:87], v[180:183]
    v_perm_b32 v120, v149, v145, s46
    v_perm_b32 v124, v149, v145, s47
    v_mfma_f32_16x16x32_bf16 v[184:187], v[248:251], v[88:91], v[184:187]
    v_perm_b32 v128, v150, v146, s46
    v_perm_b32 v132, v150, v146, s47
    v_mfma_f32_16x16x32_bf16 v[188:191], v[248:251], v[92:95], v[188:191]
    v_perm_b32 v136, v151, v147, s46
    v_perm_b32 v140, v151, v147, s47
    s_waitcnt vmcnt(5)
    v_mfma_f32_16x16x32_bf16 v[192:195], v[248:251], v[96:99], v[192:195]
    v_perm_b32 v113, v156, v152, s46
    v_perm_b32 v117, v156, v152, s47
    v_mfma_f32_16x16x32_bf16 v[196:199], v[248:251], v[100:103], v[196:199]
    v_perm_b32 v121, v157, v153, s46
    v_perm_b32 v125, v157, v153, s47
    v_mfma_f32_16x16x32_bf16 v[200:203], v[248:251], v[104:107], v[200:203]
    v_perm_b32 v129, v158, v154, s46
    v_perm_b32 v133, v158, v154, s47
    v_mfma_f32_16x16x32_bf16 v[204:207], v[248:251], v[108:111], v[204:207]
    v_perm_b32 v137, v159, v155, s46
    v_perm_b32 v141, v159, v155, s47
    s_waitcnt vmcnt(3)
    v_perm_b32 v114, v164, v160, s46
    v_perm_b32 v118, v164, v160, s47
    v_perm_b32 v122, v165, v161, s46
    v_perm_b32 v126, v165, v161, s47
    v_perm_b32 v130, v166, v162, s46
    v_perm_b32 v134, v166, v162, s47
    v_perm_b32 v138, v167, v163, s46
    v_perm_b32 v142, v167, v163, s47
    s_waitcnt vmcnt(1)
    v_perm_b32 v115, v172, v168, s46
    v_perm_b32 v119, v172, v168, s47
    v_perm_b32 v123, v173, v169, s46
    v_perm_b32 v127, v173, v169, s47
    v_mfma_f32_16x16x32_bf16 v[176:179], v[252:255], v[112:115], v[176:179]
    v_mfma_f32_16x16x32_bf16 v[180:183], v[252:255], v[116:119], v[180:183]
    v_perm_b32 v131, v174, v170, s46
    v_perm_b32 v135, v174, v170, s47
    v_mfma_f32_16x16x32_bf16 v[184:187], v[252:255], v[120:123], v[184:187]
    v_mfma_f32_16x16x32_bf16 v[188:191], v[252:255], v[124:127], v[188:191]
    v_perm_b32 v139, v175, v171, s46
    v_perm_b32 v143, v175, v171, s47
    v_mfma_f32_16x16x32_bf16 v[192:195], v[252:255], v[128:131], v[192:195]
    v_mfma_f32_16x16x32_bf16 v[196:199], v[252:255], v[132:135], v[196:199]
    v_mfma_f32_16x16x32_bf16 v[200:203], v[252:255], v[136:139], v[200:203]
    v_mfma_f32_16x16x32_bf16 v[204:207], v[252:255], v[140:143], v[204:207]
    s_cmp_lg_u32 s99, 1
    s_cbranch_scc1 L_oB
    v_and_or_b32 v16, v176, v10, s41
    v_and_or_b32 v17, v180, v10, s42
    v_and_or_b32 v18, v184, v10, s43
    v_and_or_b32 v19, v188, v10, s44
    global_store_dwordx4 v8, v[16:19], s[30:31] offset:0
    v_and_or_b32 v20, v192, v10, s41
    v_and_or_b32 v21, v196, v10, s42
    v_and_or_b32 v22, v200, v10, s43
    v_and_or_b32 v23, v204, v10, s44
    global_store_dwordx4 v8, v[20:23], s[30:31] offset:128
    s_mov_b64 exec, 1
    ds_write_b32 v11, v12 offset:1124
    s_mov_b64 exec, -1
    s_endpgm
L_oB:
    s_nop 7
    v_and_or_b32 v16, v176, v10, s41
    v_and_or_b32 v17, v180, v10, s42
    v_and_or_b32 v18, v184, v10, s43
    v_and_or_b32 v19, v188, v10, s44
    global_store_dwordx4 v8, v[16:19], s[30:31] offset:0 sc1
    v_and_or_b32 v20, v192, v10, s41
    v_and_or_b32 v21, v196, v10, s42
    v_and_or_b32 v22, v200, v10, s43
    v_and_or_b32 v23, v204, v10, s44
    global_store_dwordx4 v8, v[20:23], s[30:31] offset:128 sc1
    s_mov_b64 exec, 1
    ds_write_b32 v11, v12 offset:1124
    s_mov_b64 exec, -1
    s_endpgm
L_s2:
    v_and_b32 v2, 15, v0
    v_lshrrev_b32 v3, 4, v0
    s_mov_b32 s46, 0x05040100
    s_mov_b32 s47, 0x07060302
    v_mov_b32 v10, 0xffffff00
    v_mov_b32 v12, 1
    s_sub_u32 s53, s3, 2
    s_lshr_b32 s54, s33, 1
    s_and_b32 s55, s33, 1
    v_lshlrev_b32 v5, 13, v3
    v_lshl_add_u32 v5, v2, 4, v5
    s_lshl_b32 s36, s32, 19
    s_lshl_b32 s37, s54, 15
    s_add_u32 s36, s36, s37
    s_lshl_b32 s37, s55, 9
    s_add_u32 s36, s36, s37
    s_lshl_b32 s37, s53, 8
    s_add_u32 s36, s36, s37
    s_add_u32 s36, s36, 4096
    v_add_u32 v5, s36, v5
    v_and_b32 v13, 7, v2
    s_lshl_b32 s36, s32, 16
    s_lshr_b32 s37, s54, 1
    s_lshl_b32 s37, s37, 13
    s_add_u32 s36, s36, s37
    s_and_b32 s37, s54, 1
    s_lshl_b32 s37, s37, 6
    s_add_u32 s36, s36, s37
    s_add_u32 s36, s36, 0x41000
    v_lshrrev_b32 v6, 3, v2
    v_lshlrev_b32 v6, 7, v6
    v_lshl_add_u32 v6, v13, 8, v6
    v_lshl_add_u32 v6, v3, 4, v6
    v_add_u32 v6, s36, v6
    s_lshl_b32 s36, s32, 11
    s_lshr_b32 s37, s54, 2
    s_lshl_b32 s37, s37, 9
    s_add_u32 s37, s37, s36
    s_add_u32 s37, s37, 0x30000
    v_lshl_add_u32 v7, v13, 4, s37
    s_lshl_b32 s36, s32, 4
    s_add_u32 s36, s36, s54
    s_lshl_b32 s37, s55, 17
    s_add_u32 s37, s37, 0xc0000
    s_lshl_b32 s36, s36, 10
    s_add_u32 s37, s37, s36
    s_lshl_b32 s36, s53, 9
    s_add_u32 s37, s37, s36
    v_lshl_add_u32 v8, v2, 4, s37
    v_lshl_add_u32 v20, v2, 5, s36
    s_waitcnt lgkmcnt(0)
    s_mov_b32 s48, 0
L_sp_6:
    ds_read_b32 v21, v11 offset:1116
    s_waitcnt lgkmcnt(0)
    v_readfirstlane_b32 s34, v21
    s_nop 0
    s_cmp_ge_u32 s34, 1
    s_cbranch_scc1 L_spd_7
    s_sleep 1
    s_add_u32 s48, s48, 1
    s_cmp_lt_u32 s48, 400000
    s_cbranch_scc1 L_sp_6
L_spd_7:
    global_load_dwordx4 v[32:35], v5, s[12:13] offset:-4096 nt
    global_load_dwordx4 v[36:39], v5, s[12:13] offset:-3072 nt
    global_load_dwordx4 v[40:43], v5, s[12:13] offset:-2048 nt
    global_load_dwordx4 v[44:47], v5, s[12:13] offset:-1024 nt
    global_load_dwordx4 v[48:51], v5, s[12:13] offset:0 nt
    global_load_dwordx4 v[52:55], v5, s[12:13] offset:1024 nt
    global_load_dwordx4 v[56:59], v5, s[12:13] offset:2048 nt
    global_load_dwordx4 v[60:63], v5, s[12:13] offset:3072 nt
L_s2t:
    s_waitcnt vmcnt(6)
    v_perm_b32 v64, v36, v32, s46
    v_perm_b32 v68, v36, v32, s47
    v_perm_b32 v72, v37, v33, s46
    v_perm_b32 v76, v37, v33, s47
    v_perm_b32 v80, v38, v34, s46
    v_perm_b32 v84, v38, v34, s47
    v_perm_b32 v88, v39, v35, s46
    v_perm_b32 v92, v39, v35, s47
    s_waitcnt vmcnt(4)
    v_perm_b32 v65, v44, v40, s46
    v_perm_b32 v69, v44, v40, s47
    v_perm_b32 v73, v45, v41, s46
    v_perm_b32 v77, v45, v41, s47
    v_perm_b32 v81, v46, v42, s46
    v_perm_b32 v85, v46, v42, s47
    v_perm_b32 v89, v47, v43, s46
    v_perm_b32 v93, v47, v43, s47
    s_waitcnt vmcnt(2)
    v_perm_b32 v66, v52, v48, s46
    v_perm_b32 v70, v52, v48, s47
    v_perm_b32 v74, v53, v49, s46
    v_perm_b32 v78, v53, v49, s47
    v_perm_b32 v82, v54, v50, s46
    v_perm_b32 v86, v54, v50, s47
    v_perm_b32 v90, v55, v51, s46
    v_perm_b32 v94, v55, v51, s47
    s_waitcnt vmcnt(0)
    v_perm_b32 v67, v60, v56, s46
    v_perm_b32 v71, v60, v56, s47
    v_perm_b32 v75, v61, v57, s46
    v_perm_b32 v79, v61, v57, s47
    v_perm_b32 v83, v62, v58, s46
    v_perm_b32 v87, v62, v58, s47
    v_perm_b32 v91, v63, v59, s46
    v_perm_b32 v95, v63, v59, s47
    s_mov_b32 s48, 0
L_sp_8:
    ds_read_b32 v21, v11 offset:1112
    s_waitcnt lgkmcnt(0)
    v_readfirstlane_b32 s34, v21
    s_nop 0
    s_cmp_ge_u32 s34, 1
    s_cbranch_scc1 L_spd_9
    s_add_u32 s48, s48, 1
    s_cmp_lt_u32 s48, 400000
    s_cbranch_scc1 L_sp_8
L_spd_9:
    ds_read_b128 v[216:219], v20 offset:1536
    ds_read_b128 v[220:223], v20 offset:1552
    ds_read_b64 v[22:23], v11 offset:1088
    ds_read_b128 v[24:27], v11 offset:1168
    s_waitcnt lgkmcnt(0)
    v_readfirstlane_b32 s41, v24
    v_readfirstlane_b32 s42, v25
    v_readfirstlane_b32 s43, v26
    v_readfirstlane_b32 s44, v27
    s_mov_b32 s48, 0
L_sp_10:
    ds_read_b32 v21, v11 offset:1124
    s_waitcnt lgkmcnt(0)
    v_readfirstlane_b32 s34, v21
    s_nop 0
    s_cmp_ge_u32 s34, 1
    s_cbranch_scc1 L_spd_11
    s_add_u32 s48, s48, 1
    s_cmp_lt_u32 s48, 400000
    s_cbranch_scc1 L_sp_10
L_spd_11:
    s_waitcnt vmcnt(0)
    global_load_dwordx4 v[140:143], v7, s[30:31] offset:0 sc1
    global_load_dwordx4 v[144:147], v7, s[30:31] offset:128 sc1
    global_load_dwordx4 v[148:151], v7, s[30:31] offset:256 sc1
    global_load_dwordx4 v[152:155], v7, s[30:31] offset:384 sc1
    global_load_dwordx4 v[160:163], v6, s[30:31] offset:-4096 sc1
    global_load_dwordx4 v[164:167], v6, s[30:31] offset:-2048 sc1
    global_load_dwordx4 v[168:171], v6, s[30:31] offset:0 sc1
    global_load_dwordx4 v[172:175], v6, s[30:31] offset:2048 sc1
L_noiss:
    s_mov_b64 exec, 1
    ds_add_u32 v11, v12 offset:1120
    s_mov_b64 exec, -1
    s_mov_b32 s48, 0
L_pl_12:
    s_waitcnt vmcnt(0)
    v_msad_u8 v96, v140, s41, 0
    v_msad_u8 v97, v144, s41, 0
    v_msad_u8 v98, v148, s41, 0
    v_msad_u8 v99, v152, s41, 0
    v_msad_u8 v100, v160, s41, 0
    v_msad_u8 v101, v164, s41, 0
    v_msad_u8 v102, v168, s41, 0
    v_msad_u8 v103, v172, s41, 0
    v_msad_u8 v96, v141, s42, v96
    v_msad_u8 v97, v145, s42, v97
    v_msad_u8 v98, v149, s42, v98
    v_msad_u8 v99, v153, s42, v99
    v_msad_u8 v100, v161, s42, v100
    v_msad_u8 v101, v165, s42, v101
    v_msad_u8 v102, v169, s42, v102
    v_msad_u8 v103, v173, s42, v103
    v_msad_u8 v96, v142, s43, v96
    v_msad_u8 v97, v146, s43, v97
    v_msad_u8 v98, v150, s43, v98
    v_msad_u8 v99, v154, s43, v99
    v_msad_u8 v100, v162, s43, v100
    v_msad_u8 v101, v166, s43, v101
    v_msad_u8 v102, v170, s43, v102
    v_msad_u8 v103, v174, s43, v103
    v_msad_u8 v96, v143, s44, v96
    v_msad_u8 v97, v147, s44, v97
    v_msad_u8 v98, v151, s44, v98
    v_msad_u8 v99, v155, s44, v99
    v_msad_u8 v100, v163, s44, v100
    v_msad_u8 v101, v167, s44, v101
    v_msad_u8 v102, v171, s44, v102
    v_msad_u8 v103, v175, s44, v103
    v_cmp_ne_u32 s[56:57], 0, v96
    v_cmp_ne_u32 s[58:59], 0, v97
    v_cmp_ne_u32 s[60:61], 0, v98
    v_cmp_ne_u32 s[62:63], 0, v99
    v_cmp_ne_u32 s[36:37], 0, v100
    v_cmp_ne_u32 s[38:39], 0, v101
    v_cmp_ne_u32 s[96:97], 0, v102
    v_cmp_ne_u32 s[98:99], 0, v103
    s_or_b64 s[50:51], s[56:57], s[58:59]
    s_or_b64 s[50:51], s[50:51], s[60:61]
    s_or_b64 s[50:51], s[50:51], s[62:63]
    s_or_b64 s[50:51], s[50:51], s[36:37]
    s_or_b64 s[50:51], s[50:51], s[38:39]
    s_or_b64 s[50:51], s[50:51], s[96:97]
    s_or_b64 s[50:51], s[50:51], s[98:99]
    s_cbranch_scc0 L_pld_13
    s_add_u32 s48, s48, 1
    s_cmp_ge_u32 s48, 400000
    s_cbranch_scc1 L_pld_13
    s_mov_b64 exec, s[56:57]
    s_cbranch_execz L_pls_14
    global_load_dwordx4 v[140:143], v7, s[30:31] offset:0 sc1
L_pls_14:
    s_mov_b64 exec, s[58:59]
    s_cbranch_execz L_pls_15
    global_load_dwordx4 v[144:147], v7, s[30:31] offset:128 sc1
L_pls_15:
    s_mov_b64 exec, s[60:61]
    s_cbranch_execz L_pls_16
    global_load_dwordx4 v[148:151], v7, s[30:31] offset:256 sc1
L_pls_16:
    s_mov_b64 exec, s[62:63]
    s_cbranch_execz L_pls_17
    global_load_dwordx4 v[152:155], v7, s[30:31] offset:384 sc1
L_pls_17:
    s_mov_b64 exec, s[36:37]
    s_cbranch_execz L_pls_18
    global_load_dwordx4 v[160:163], v6, s[30:31] offset:-4096 sc1
L_pls_18:
    s_mov_b64 exec, s[38:39]
    s_cbranch_execz L_pls_19
    global_load_dwordx4 v[164:167], v6, s[30:31] offset:-2048 sc1
L_pls_19:
    s_mov_b64 exec, s[96:97]
    s_cbranch_execz L_pls_20
    global_load_dwordx4 v[168:171], v6, s[30:31] offset:0 sc1
L_pls_20:
    s_mov_b64 exec, s[98:99]
    s_cbranch_execz L_pls_21
    global_load_dwordx4 v[172:175], v6, s[30:31] offset:2048 sc1
L_pls_21:
    s_mov_b64 exec, -1
    s_branch L_pl_12
L_pld_13:
    v_and_b32 v140, v140, v10
    v_and_b32 v144, v144, v10
    v_and_b32 v148, v148, v10
    v_and_b32 v152, v152, v10
    v_max3_f32 v26, v140, v144, v148
    v_max_f32 v26, v26, v152
    s_nop 1
    v_max_f32_dpp v26, v26, v26 quad_perm:[1,0,3,2] row_mask:0xf bank_mask:0xf
    s_nop 1
    v_max_f32_dpp v26, v26, v26 quad_perm:[2,3,0,1] row_mask:0xf bank_mask:0xf
    s_nop 1
    v_max_f32_dpp v26, v26, v26 row_half_mirror row_mask:0xf bank_mask:0xf
    v_sub_f32 v156, v140, v26
    v_sub_f32 v157, v144, v26
    v_sub_f32 v158, v148, v26
    v_sub_f32 v159, v152, v26
    v_exp_f32 v156, v156
    v_exp_f32 v157, v157
    v_exp_f32 v158, v158
    v_exp_f32 v159, v159
    v_mul_f32 v176, v156, v160
    v_mul_f32 v177, v156, v161
    v_mul_f32 v178, v156, v162
    v_mul_f32 v179, v156, v163
    v_mul_f32 v27, v156, v141
    v_fmac_f32 v176, v157, v164
    v_fmac_f32 v177, v157, v165
    v_fmac_f32 v178, v157, v166
    v_fmac_f32 v179, v157, v167
    v_fmac_f32 v27, v157, v145
    v_fmac_f32 v176, v158, v168
    v_fmac_f32 v177, v158, v169
    v_fmac_f32 v178, v158, v170
    v_fmac_f32 v179, v158, v171
    v_fmac_f32 v27, v158, v149
    v_fmac_f32 v176, v159, v172
    v_fmac_f32 v177, v159, v173
    v_fmac_f32 v178, v159, v174
    v_fmac_f32 v179, v159, v175
    v_fmac_f32 v27, v159, v153
    v_add_f32_dpp v176, v176, v176 quad_perm:[1,0,3,2] row_mask:0xf bank_mask:0xf
    v_add_f32_dpp v177, v177, v177 quad_perm:[1,0,3,2] row_mask:0xf bank_mask:0xf
    v_add_f32_dpp v178, v178, v178 quad_perm:[1,0,3,2] row_mask:0xf bank_mask:0xf
    v_add_f32_dpp v179, v179, v179 quad_perm:[1,0,3,2] row_mask:0xf bank_mask:0xf
    v_add_f32_dpp v27, v27, v27 quad_perm:[1,0,3,2] row_mask:0xf bank_mask:0xf
    v_add_f32_dpp v176, v176, v176 quad_perm:[2,3,0,1] row_mask:0xf bank_mask:0xf
    v_add_f32_dpp v177, v177, v177 quad_perm:[2,3,0,1] row_mask:0xf bank_mask:0xf
    v_add_f32_dpp v178, v178, v178 quad_perm:[2,3,0,1] row_mask:0xf bank_mask:0xf
    v_add_f32_dpp v179, v179, v179 quad_perm:[2,3,0,1] row_mask:0xf bank_mask:0xf
    v_add_f32_dpp v27, v27, v27 quad_perm:[2,3,0,1] row_mask:0xf bank_mask:0xf
    v_add_f32_dpp v176, v176, v176 row_half_mirror row_mask:0xf bank_mask:0xf
    v_add_f32_dpp v177, v177, v177 row_half_mirror row_mask:0xf bank_mask:0xf
    v_add_f32_dpp v178, v178, v178 row_half_mirror row_mask:0xf bank_mask:0xf
    v_add_f32_dpp v179, v179, v179 row_half_mirror row_mask:0xf bank_mask:0xf
    v_add_f32_dpp v27, v27, v27 row_half_mirror row_mask:0xf bank_mask:0xf
    v_cvt_pk_bf16_f32 v180, v176, v177
    v_cvt_pk_bf16_f32 v181, v178, v179
    v_rcp_f32 v27, v27
    v_mov_b32_dpp v182, v180 row_ror:8 row_mask:0xf bank_mask:0xf
    v_mov_b32_dpp v183, v181 row_ror:8 row_mask:0xf bank_mask:0xf
    v_mul_f32 v22, v22, v27
    s_nop 0
    v_mfma_f32_16x16x32_bf16 v[184:187], v[180:183], v[64:67], 0
    v_mfma_f32_16x16x32_bf16 v[188:191], v[180:183], v[68:71], 0
    v_mfma_f32_16x16x32_bf16 v[192:195], v[180:183], v[72:75], 0
    v_mfma_f32_16x16x32_bf16 v[196:199], v[180:183], v[76:79], 0
    v_mfma_f32_16x16x32_bf16 v[200:203], v[180:183], v[80:83], 0
    v_mfma_f32_16x16x32_bf16 v[204:207], v[180:183], v[84:87], 0
    v_mfma_f32_16x16x32_bf16 v[208:211], v[180:183], v[88:91], 0
    v_mfma_f32_16x16x32_bf16 v[212:215], v[180:183], v[92:95], 0
    s_mov_b64 exec, 0xffff
    v_fma_f32 v216, v184, v22, v216
    v_fma_f32 v217, v188, v22, v217
    v_fma_f32 v218, v192, v22, v218
    v_fma_f32 v219, v196, v22, v219
    v_and_or_b32 v216, v216, v10, s41
    v_and_or_b32 v217, v217, v10, s42
    v_and_or_b32 v218, v218, v10, s43
    v_and_or_b32 v219, v219, v10, s44
    global_store_dwordx4 v8, v[216:219], s[30:31] offset:0 sc1
    v_fma_f32 v220, v200, v22, v220
    v_fma_f32 v221, v204, v22, v221
    v_fma_f32 v222, v208, v22, v222
    v_fma_f32 v223, v212, v22, v223
    v_and_or_b32 v220, v220, v10, s41
    v_and_or_b32 v221, v221, v10, s42
    v_and_or_b32 v222, v222, v10, s43
    v_and_or_b32 v223, v223, v10, s44
    global_store_dwordx4 v8, v[220:223], s[30:31] offset:256 sc1
    s_mov_b64 exec, 1
    ds_add_u32 v11, v12 offset:1128
    s_mov_b64 exec, -1
    s_endpgm
L_w0c:
    v_lshlrev_b32 v14, 4, v0
    s_lshr_b32 s53, s36, 1
    s_lshl_b32 s37, s39, 2
    s_add_u32 s53, s53, s37
    v_lshrrev_b32 v15, 4, v0
    s_lshl_b32 s37, s53, 5
    v_lshl_add_u32 v55, v15, 3, s37
    v_and_b32 v56, 1, v15
    v_lshlrev_b32 v56, 2, v56
    v_lshrrev_b32 v57, 1, v15
    v_lshl_add_u32 v56, v57, 1, v56
    s_lshl_b32 s37, s35, 2
    s_and_b32 s38, s32, 3
    s_add_u32 s37, s37, s38
    s_lshl_b32 s37, s37, 3
    s_add_u32 s54, s37, s36
    s_and_b32 s37, s54, 0x60
    s_lshl_b32 s37, s37, 2
    s_and_b32 s38, s54, 15
    s_lshl_b32 s38, s38, 3
    s_add_u32 s37, s37, s38
    s_bfe_u32 s38, s54, 0x10004
    s_lshl_b32 s38, s38, 2
    s_add_u32 s37, s37, s38
    s_lshl_b32 s37, s37, 1
    v_add_u32 v54, s37, v56
    s_lshl_b32 s37, s32, 13
    s_add_u32 s37, s37, 0x11000
    v_add_u32 v19, s37, v14
    v_lshlrev_b32 v20, 8, v2
    v_lshl_add_u32 v20, v15, 4, v20
    s_lshl_b32 s37, s39, 11
    s_lshr_b32 s38, s36, 1
    s_lshl_b32 s38, s38, 6
    s_add_u32 s37, s37, s38
    s_add_u32 s37, s37, 0x20000
    v_add_u32 v20, s37, v20
    v_lshrrev_b32 v21, 5, v0
    v_mul_u32_u24 v21, 272, v21
    v_and_b32 v22, 31, v0
    v_lshl_add_u32 v21, v22, 3, v21
    v_and_b32 v22, 15, v0
    v_lshlrev_b32 v23, 4, v22
    v_lshl_add_u32 v22, v15, 12, v23
    s_lshl_b32 s37, s53, 14
    s_and_b32 s38, s33, 1
    s_lshl_b32 s38, s38, 9
    s_add_u32 s37, s37, s38
    v_add_u32 v22, s37, v22
    v_lshlrev_b32 v23, 1, v23
    s_lshr_b32 s38, s54, 6
    s_lshl_b32 s38, s38, 17
    s_and_b32 s37, s54, 63
    s_lshl_b32 s37, s37, 4
    s_add_u32 s37, s37, s38
    s_add_u32 s37, s37, 0xc0000
    v_lshlrev_b32 v24, 10, v0
    v_add_u32 v24, s37, v24
    v_add_u32 v25, 0x10000, v24
    global_load_dwordx4 v[44:47], v14, s[4:5]
    global_load_dwordx4 v[48:51], v14, s[24:25]
    global_load_dwordx2 v[52:53], v55, s[18:19]
    global_load_ushort v55, v54, s[22:23]
    s_mov_b32 s48, 0
L_sp_22:
    ds_read_b32 v26, v11 offset:1140
    s_waitcnt lgkmcnt(0)
    v_readfirstlane_b32 s34, v26
    s_nop 0
    s_cmp_ge_u32 s34, 1
    s_cbranch_scc1 L_spd_23
    s_add_u32 s48, s48, 1
    s_cmp_lt_u32 s48, 400000
    s_cbranch_scc1 L_sp_22
L_spd_23:
    global_load_dwordx4 v[64:67], v19, s[30:31] offset:-4096 sc1
    global_load_dwordx4 v[68:71], v19, s[30:31] offset:-3072 sc1
    global_load_dwordx4 v[72:75], v19, s[30:31] offset:-2048 sc1
    global_load_dwordx4 v[76:79], v19, s[30:31] offset:-1024 sc1
    global_load_dwordx4 v[80:83], v19, s[30:31] offset:0 sc1
    global_load_dwordx4 v[84:87], v19, s[30:31] offset:1024 sc1
    global_load_dwordx4 v[88:91], v19, s[30:31] offset:2048 sc1
    global_load_dwordx4 v[92:95], v19, s[30:31] offset:3072 sc1
    global_load_dwordx4 v[100:103], v20, s[30:31] offset:0 sc1
    s_mov_b64 exec, s[50:51]
    global_load_dwordx4 v[200:203], v22, s[20:21] offset:0 nt
    global_load_dwordx4 v[204:207], v22, s[20:21] offset:1024 nt
    global_load_dwordx4 v[208:211], v22, s[20:21] offset:2048 nt
    global_load_dwordx4 v[212:215], v22, s[20:21] offset:3072 nt
    global_load_dwordx4 v[216:219], v22, s[20:21] offset:256 nt
    global_load_dwordx4 v[220:223], v22, s[20:21] offset:1280 nt
    global_load_dwordx4 v[224:227], v22, s[20:21] offset:2304 nt
    global_load_dwordx4 v[228:231], v22, s[20:21] offset:3328 nt
    s_mov_b64 exec, -1
    s_waitcnt vmcnt(17)
    v_lshlrev_b32 v172, 16, v44
    v_and_b32 v173, 0xffff0000, v44
    v_lshlrev_b32 v180, 16, v48
    v_and_b32 v181, 0xffff0000, v48
    v_lshlrev_b32 v174, 16, v45
    v_and_b32 v175, 0xffff0000, v45
    v_lshlrev_b32 v182, 16, v49
    v_and_b32 v183, 0xffff0000, v49
    v_lshlrev_b32 v176, 16, v46
    v_and_b32 v177, 0xffff0000, v46
    v_lshlrev_b32 v184, 16, v50
    v_and_b32 v185, 0xffff0000, v50
    v_lshlrev_b32 v178, 16, v47
    v_and_b32 v179, 0xffff0000, v47
    v_lshlrev_b32 v186, 16, v51
    v_and_b32 v187, 0xffff0000, v51
    v_mul_f32 v172, v172, v180
    v_mul_f32 v173, v173, v181
    v_mul_f32 v174, v174, v182
    v_mul_f32 v175, v175, v183
    v_mul_f32 v176, v176, v184
    v_mul_f32 v177, v177, v185
    v_mul_f32 v178, v178, v186
    v_mul_f32 v179, v179, v187
    v_cvt_pk_bf16_f32 v180, v172, v173
    v_cvt_pk_bf16_f32 v181, v174, v175
    v_cvt_pk_bf16_f32 v182, v176, v177
    v_cvt_pk_bf16_f32 v183, v178, v179
    v_mov_b32 v56, 0
    v_mov_b32 v57, 0x3f803f80
    v_dot2c_f32_bf16 v56, v180, v57
    v_dot2c_f32_bf16 v56, v181, v57
    v_dot2c_f32_bf16 v56, v182, v57
    v_dot2c_f32_bf16 v56, v183, v57
    s_nop 2
    v_add_f32_dpp v56, v56, v56 quad_perm:[1,0,3,2] row_mask:0xf bank_mask:0xf
    s_nop 1
    v_add_f32_dpp v56, v56, v56 quad_perm:[2,3,0,1] row_mask:0xf bank_mask:0xf
    s_nop 1
    v_add_f32_dpp v56, v56, v56 row_half_mirror row_mask:0xf bank_mask:0xf
    s_nop 1
    v_add_f32_dpp v56, v56, v56 row_mirror row_mask:0xf bank_mask:0xf
    v_mov_b32 v57, v56
    s_nop 1
    v_permlane16_swap_b32 v56, v57
    v_add_f32 v56, v56, v57
    v_mov_b32 v57, v56
    s_nop 1
    v_permlane32_swap_b32 v56, v57
    v_add_f32 v56, v56, v57
    v_cvt_pk_bf16_f32 v56, v56, v56
    v_lshlrev_b32 v56, 16, v56
    v_mul_f32 v56, 0xbfb8aa3b, v56
    v_exp_f32 v56, v56
    s_nop 0
    v_add_f32 v56, 1.0, v56
    v_rcp_f32 v56, v56
    s_nop 0
    v_cvt_pk_bf16_f32 v58, v56, v56
    v_lshlrev_b32 v58, 16, v58
    v_sub_f32 v59, 1.0, v58
    v_cvt_pk_bf16_f32 v59, v59, v59
    v_lshlrev_b32 v59, 16, v59
    s_mov_b32 s98, 0
    s_mov_b32 s48, 0
    s_waitcnt vmcnt(8)
    s_branch L_pl1_26
L_pl_24:
    s_waitcnt vmcnt(0)
L_pl1_26:
    v_msad_u8 v26, v64, s41, 0
    v_msad_u8 v27, v65, s42, 0
    v_msad_u8 v26, v66, s43, v26
    v_msad_u8 v27, v67, s44, v27
    v_msad_u8 v26, v68, s41, v26
    v_msad_u8 v27, v69, s42, v27
    v_msad_u8 v26, v70, s43, v26
    v_msad_u8 v27, v71, s44, v27
    v_msad_u8 v26, v72, s41, v26
    v_msad_u8 v27, v73, s42, v27
    v_msad_u8 v26, v74, s43, v26
    v_msad_u8 v27, v75, s44, v27
    v_msad_u8 v26, v76, s41, v26
    v_msad_u8 v27, v77, s42, v27
    v_msad_u8 v26, v78, s43, v26
    v_msad_u8 v27, v79, s44, v27
    v_msad_u8 v26, v80, s41, v26
    v_msad_u8 v27, v81, s42, v27
    v_msad_u8 v26, v82, s43, v26
    v_msad_u8 v27, v83, s44, v27
    v_msad_u8 v26, v84, s41, v26
    v_msad_u8 v27, v85, s42, v27
    v_msad_u8 v26, v86, s43, v26
    v_msad_u8 v27, v87, s44, v27
    v_msad_u8 v26, v88, s41, v26
    v_msad_u8 v27, v89, s42, v27
    v_msad_u8 v26, v90, s43, v26
    v_msad_u8 v27, v91, s44, v27
    v_msad_u8 v26, v92, s41, v26
    v_msad_u8 v27, v93, s42, v27
    v_msad_u8 v26, v94, s43, v26
    v_msad_u8 v27, v95, s44, v27
    v_or_b32 v26, v26, v27
    v_cmp_ne_u32 vcc, 0, v26
    s_cbranch_vccz L_pld_25
    s_add_u32 s48, s48, 1
    s_cmp_ge_u32 s48, 400000
    s_cbranch_scc1 L_pld_25
    s_cmp_lg_u32 s48, 2
    s_cbranch_scc1 L_of_27
    s_cmp_lg_u32 s98, 0
    s_cbranch_scc1 L_qb_28
    s_mov_b32 s98, 1
    s_mov_b64 exec, s[96:97]
    global_store_dwordx4 v198, v[164:167], s[30:31] offset:0 sc1
    s_cmp_eq_u32 s52, 0
    s_cbranch_scc1 L_qb_29
    global_store_dwordx4 v199, v[28:31], s[30:31] offset:0 sc1
L_qb_29:
    s_mov_b64 exec, -1
L_qb_28:
L_of_27:
    v_msad_u8 v26, v64, s41, 0
    v_msad_u8 v26, v65, s42, v26
    v_msad_u8 v26, v66, s43, v26
    v_msad_u8 v26, v67, s44, v26
    v_cmp_ne_u32 vcc, 0, v26
    s_nop 0
    s_mov_b64 exec, vcc
    s_cbranch_execz L_pls_30
    global_load_dwordx4 v[64:67], v19, s[30:31] offset:-4096 sc1
L_pls_30:
    s_mov_b64 exec, -1
    v_msad_u8 v26, v68, s41, 0
    v_msad_u8 v26, v69, s42, v26
    v_msad_u8 v26, v70, s43, v26
    v_msad_u8 v26, v71, s44, v26
    v_cmp_ne_u32 vcc, 0, v26
    s_nop 0
    s_mov_b64 exec, vcc
    s_cbranch_execz L_pls_31
    global_load_dwordx4 v[68:71], v19, s[30:31] offset:-3072 sc1
L_pls_31:
    s_mov_b64 exec, -1
    v_msad_u8 v26, v72, s41, 0
    v_msad_u8 v26, v73, s42, v26
    v_msad_u8 v26, v74, s43, v26
    v_msad_u8 v26, v75, s44, v26
    v_cmp_ne_u32 vcc, 0, v26
    s_nop 0
    s_mov_b64 exec, vcc
    s_cbranch_execz L_pls_32
    global_load_dwordx4 v[72:75], v19, s[30:31] offset:-2048 sc1
L_pls_32:
    s_mov_b64 exec, -1
    v_msad_u8 v26, v76, s41, 0
    v_msad_u8 v26, v77, s42, v26
    v_msad_u8 v26, v78, s43, v26
    v_msad_u8 v26, v79, s44, v26
    v_cmp_ne_u32 vcc, 0, v26
    s_nop 0
    s_mov_b64 exec, vcc
    s_cbranch_execz L_pls_33
    global_load_dwordx4 v[76:79], v19, s[30:31] offset:-1024 sc1
L_pls_33:
    s_mov_b64 exec, -1
    v_msad_u8 v26, v80, s41, 0
    v_msad_u8 v26, v81, s42, v26
    v_msad_u8 v26, v82, s43, v26
    v_msad_u8 v26, v83, s44, v26
    v_cmp_ne_u32 vcc, 0, v26
    s_nop 0
    s_mov_b64 exec, vcc
    s_cbranch_execz L_pls_34
    global_load_dwordx4 v[80:83], v19, s[30:31] offset:0 sc1
L_pls_34:
    s_mov_b64 exec, -1
    v_msad_u8 v26, v84, s41, 0
    v_msad_u8 v26, v85, s42, v26
    v_msad_u8 v26, v86, s43, v26
    v_msad_u8 v26, v87, s44, v26
    v_cmp_ne_u32 vcc, 0, v26
    s_nop 0
    s_mov_b64 exec, vcc
    s_cbranch_execz L_pls_35
    global_load_dwordx4 v[84:87], v19, s[30:31] offset:1024 sc1
L_pls_35:
    s_mov_b64 exec, -1
    v_msad_u8 v26, v88, s41, 0
    v_msad_u8 v26, v89, s42, v26
    v_msad_u8 v26, v90, s43, v26
    v_msad_u8 v26, v91, s44, v26
    v_cmp_ne_u32 vcc, 0, v26
    s_nop 0
    s_mov_b64 exec, vcc
    s_cbranch_execz L_pls_36
    global_load_dwordx4 v[88:91], v19, s[30:31] offset:2048 sc1
L_pls_36:
    s_mov_b64 exec, -1
    v_msad_u8 v26, v92, s41, 0
    v_msad_u8 v26, v93, s42, v26
    v_msad_u8 v26, v94, s43, v26
    v_msad_u8 v26, v95, s44, v26
    v_cmp_ne_u32 vcc, 0, v26
    s_nop 0
    s_mov_b64 exec, vcc
    s_cbranch_execz L_pls_37
    global_load_dwordx4 v[92:95], v19, s[30:31] offset:3072 sc1
L_pls_37:
    s_mov_b64 exec, -1
    s_branch L_pl_24
L_pld_25:
    v_xor_b32 v104, s55, v64
    v_xor_b32 v105, s55, v68
    v_xor_b32 v106, s55, v72
    v_xor_b32 v107, s55, v76
    v_xor_b32 v108, s55, v80
    v_xor_b32 v109, s55, v84
    v_xor_b32 v110, s55, v88
    v_xor_b32 v111, s55, v92
    v_pk_add_f32 v[64:65], v[64:65], v[72:73]
    v_pk_add_f32 v[80:81], v[80:81], v[88:89]
    v_pk_add_f32 v[66:67], v[66:67], v[74:75]
    v_pk_add_f32 v[82:83], v[82:83], v[90:91]
    v_pk_add_f32 v[64:65], v[64:65], v[80:81]
    v_pk_add_f32 v[66:67], v[66:67], v[82:83]
    v_cvt_pk_bf16_f32 v96, v64, v65
    v_cvt_pk_bf16_f32 v97, v66, v67
    ds_write_b64 v21, v[96:97] offset:0
    v_pk_add_f32 v[68:69], v[68:69], v[76:77]
    v_pk_add_f32 v[84:85], v[84:85], v[92:93]
    v_pk_add_f32 v[70:71], v[70:71], v[78:79]
    v_pk_add_f32 v[86:87], v[86:87], v[94:95]
    v_pk_add_f32 v[68:69], v[68:69], v[84:85]
    v_pk_add_f32 v[70:71], v[70:71], v[86:87]
    v_cvt_pk_bf16_f32 v98, v68, v69
    v_cvt_pk_bf16_f32 v99, v70, v71
    ds_write_b64 v21, v[98:99] offset:544
    s_mov_b64 exec, 1
    ds_write_b32 v11, v12 offset:1104
    s_mov_b64 exec, -1
    s_setprio 0
    v_or3_b32 v104, v104, v105, v106
    v_or3_b32 v107, v107, v108, v109
    v_or3_b32 v104, v104, v110, v111
    v_or_b32 v104, v104, v107
    v_and_b32 v104, 0x700, v104
    v_cmp_ne_u32 vcc, 0, v104
    s_nop 0
    s_cmp_lg_u64 vcc, 0
    s_cselect_b32 s99, 2, 1
    v_mov_b32 v104, s99
    s_mov_b64 exec, 1
    ds_write_b32 v11, v104 offset:1136
    s_mov_b64 exec, -1
    s_cmp_eq_u32 s99, 1
    s_cbranch_scc1 L_m1
    s_cmp_lg_u32 s98, 0
    s_cbranch_scc1 L_qb_38
    s_mov_b32 s98, 1
    s_mov_b64 exec, s[96:97]
    global_store_dwordx4 v198, v[164:167], s[30:31] offset:0 sc1
    s_cmp_eq_u32 s52, 0
    s_cbranch_scc1 L_qb_39
    global_store_dwordx4 v199, v[28:31], s[30:31] offset:0 sc1
L_qb_39:
    s_mov_b64 exec, -1
L_qb_38:
L_m1:
    s_cmp_eq_u32 s52, 0
    s_cbranch_scc1 L_nomlp
    s_mov_b32 s48, 0
    s_waitcnt vmcnt(8)
    s_branch L_pl1_42
L_pl_40:
    s_waitcnt vmcnt(0)
L_pl1_42:
    v_msad_u8 v26, v100, s41, 0
    v_msad_u8 v26, v101, s42, v26
    v_msad_u8 v26, v102, s43, v26
    v_msad_u8 v26, v103, s44, v26
    v_cmp_ne_u32 s[56:57], 0, v26
    s_nop 0
    s_cmp_lg_u64 s[56:57], 0
    s_cbranch_scc0 L_pld_41
    s_add_u32 s48, s48, 1
    s_cmp_ge_u32 s48, 400000
    s_cbranch_scc1 L_pld_41
    s_sleep 1
    s_mov_b64 exec, s[56:57]
    s_cbranch_execz L_pls_43
    global_load_dwordx4 v[100:103], v20, s[30:31] offset:0 sc1
L_pls_43:
    s_mov_b64 exec, -1
    s_branch L_pl_40
L_pld_41:
    v_add_f32_dpp v100, v100, v100 quad_perm:[1,0,3,2] row_mask:0xf bank_mask:0xf
    v_add_f32_dpp v101, v101, v101 quad_perm:[1,0,3,2] row_mask:0xf bank_mask:0xf
    v_add_f32_dpp v102, v102, v102 quad_perm:[1,0,3,2] row_mask:0xf bank_mask:0xf
    v_add_f32_dpp v103, v103, v103 quad_perm:[1,0,3,2] row_mask:0xf bank_mask:0xf
    v_add_f32_dpp v100, v100, v100 quad_perm:[2,3,0,1] row_mask:0xf bank_mask:0xf
    v_add_f32_dpp v101, v101, v101 quad_perm:[2,3,0,1] row_mask:0xf bank_mask:0xf
    v_add_f32_dpp v102, v102, v102 quad_perm:[2,3,0,1] row_mask:0xf bank_mask:0xf
    v_add_f32_dpp v103, v103, v103 quad_perm:[2,3,0,1] row_mask:0xf bank_mask:0xf
    v_add_f32_dpp v100, v100, v100 row_half_mirror row_mask:0xf bank_mask:0xf
    v_add_f32_dpp v101, v101, v101 row_half_mirror row_mask:0xf bank_mask:0xf
    v_add_f32_dpp v102, v102, v102 row_half_mirror row_mask:0xf bank_mask:0xf
    v_add_f32_dpp v103, v103, v103 row_half_mirror row_mask:0xf bank_mask:0xf
    v_lshlrev_b32 v104, 16, v52
    v_and_b32 v105, 0xffff0000, v52
    v_lshlrev_b32 v106, 16, v53
    v_and_b32 v107, 0xffff0000, v53
    v_cvt_pk_bf16_f32 v108, v100, v101
    v_cvt_pk_bf16_f32 v109, v102, v103
    v_lshlrev_b32 v100, 16, v108
    v_and_b32 v101, 0xffff0000, v108
    v_lshlrev_b32 v102, 16, v109
    v_and_b32 v103, 0xffff0000, v109
    v_add_f32 v100, v100, v104
    v_add_f32 v101, v101, v105
    v_add_f32 v102, v102, v106
    v_add_f32 v103, v103, v107
    v_cvt_pk_bf16_f32 v108, v100, v101
    v_cvt_pk_bf16_f32 v109, v102, v103
    v_lshlrev_b32 v100, 16, v108
    v_and_b32 v101, 0xffff0000, v108
    v_lshlrev_b32 v102, 16, v109
    v_and_b32 v103, 0xffff0000, v109
    s_mov_b32 s34, 0xbdd2d3e8
    v_mov_b32 v108, 0xc0135761
    v_mul_f32 v104, v100, v100
    v_mul_f32 v105, v101, v101
    v_mul_f32 v106, v102, v102
    v_mul_f32 v107, v103, v103
    v_fma_f32 v104, v104, s34, v108
    v_fma_f32 v105, v105, s34, v108
    v_fma_f32 v106, v106, s34, v108
    v_fma_f32 v107, v107, s34, v108
    v_mul_f32 v104, v104, v100
    v_mul_f32 v105, v105, v101
    v_mul_f32 v106, v106, v102
    v_mul_f32 v107, v107, v103
    v_exp_f32 v104, v104
    v_exp_f32 v105, v105
    v_exp_f32 v106, v106
    v_exp_f32 v107, v107
    v_add_f32 v104, 1.0, v104
    v_add_f32 v105, 1.0, v105
    v_add_f32 v106, 1.0, v106
    v_add_f32 v107, 1.0, v107
    v_rcp_f32 v104, v104
    v_rcp_f32 v105, v105
    v_rcp_f32 v106, v106
    v_rcp_f32 v107, v107
    v_mul_f32 v100, v100, v104
    v_mul_f32 v101, v101, v105
    v_mul_f32 v102, v102, v106
    v_mul_f32 v103, v103, v107
    v_cvt_pk_bf16_f32 v60, v100, v101
    v_cvt_pk_bf16_f32 v61, v102, v103
    s_waitcnt vmcnt(6)
    v_perm_b32 v128, v204, v200, s46
    v_perm_b32 v130, v204, v200, s47
    v_perm_b32 v132, v205, v201, s46
    v_perm_b32 v134, v205, v201, s47
    v_perm_b32 v136, v206, v202, s46
    v_perm_b32 v138, v206, v202, s47
    v_perm_b32 v140, v207, v203, s46
    v_perm_b32 v142, v207, v203, s47
    s_waitcnt vmcnt(4)
    v_perm_b32 v129, v212, v208, s46
    v_perm_b32 v131, v212, v208, s47
    v_perm_b32 v133, v213, v209, s46
    v_perm_b32 v135, v213, v209, s47
    v_perm_b32 v137, v214, v210, s46
    v_perm_b32 v139, v214, v210, s47
    v_perm_b32 v141, v215, v211, s46
    v_perm_b32 v143, v215, v211, s47
    v_mfma_f32_16x16x16_bf16 v[64:67], v[60:61], v[128:129], 0
    v_mfma_f32_16x16x16_bf16 v[68:71], v[60:61], v[130:131], 0
    v_mfma_f32_16x16x16_bf16 v[72:75], v[60:61], v[132:133], 0
    v_mfma_f32_16x16x16_bf16 v[76:79], v[60:61], v[134:135], 0
    v_mfma_f32_16x16x16_bf16 v[80:83], v[60:61], v[136:137], 0
    v_mfma_f32_16x16x16_bf16 v[84:87], v[60:61], v[138:139], 0
    v_mfma_f32_16x16x16_bf16 v[88:91], v[60:61], v[140:141], 0
    v_mfma_f32_16x16x16_bf16 v[92:95], v[60:61], v[142:143], 0
    s_waitcnt vmcnt(2)
    v_perm_b32 v144, v220, v216, s46
    v_perm_b32 v146, v220, v216, s47
    v_perm_b32 v148, v221, v217, s46
    v_perm_b32 v150, v221, v217, s47
    v_perm_b32 v152, v222, v218, s46
    v_perm_b32 v154, v222, v218, s47
    v_perm_b32 v156, v223, v219, s46
    v_perm_b32 v158, v223, v219, s47
    s_waitcnt vmcnt(0)
    v_perm_b32 v145, v228, v224, s46
    v_perm_b32 v147, v228, v224, s47
    v_perm_b32 v149, v229, v225, s46
    v_perm_b32 v151, v229, v225, s47
    v_perm_b32 v153, v230, v226, s46
    v_perm_b32 v155, v230, v226, s47
    v_perm_b32 v157, v231, v227, s46
    v_perm_b32 v159, v231, v227, s47
    v_mfma_f32_16x16x16_bf16 v[96:99], v[60:61], v[144:145], 0
    v_mfma_f32_16x16x16_bf16 v[100:103], v[60:61], v[146:147], 0
    v_mfma_f32_16x16x16_bf16 v[104:107], v[60:61], v[148:149], 0
    v_mfma_f32_16x16x16_bf16 v[108:111], v[60:61], v[150:151], 0
    v_mfma_f32_16x16x16_bf16 v[112:115], v[60:61], v[152:153], 0
    v_mfma_f32_16x16x16_bf16 v[116:119], v[60:61], v[154:155], 0
    v_mfma_f32_16x16x16_bf16 v[120:123], v[60:61], v[156:157], 0
    v_mfma_f32_16x16x16_bf16 v[124:127], v[60:61], v[158:159], 0
    v_mul_f32 v168, v59, v64
    v_mul_f32 v169, v59, v68
    v_mul_f32 v170, v59, v72
    v_mul_f32 v171, v59, v76
    v_mul_f32 v172, v59, v80
    v_mul_f32 v173, v59, v84
    v_mul_f32 v174, v59, v88
    v_mul_f32 v175, v59, v92
    v_mul_f32 v176, v59, v96
    v_mul_f32 v177, v59, v100
    v_mul_f32 v178, v59, v104
    v_mul_f32 v179, v59, v108
    v_mul_f32 v180, v59, v112
    v_mul_f32 v181, v59, v116
    v_mul_f32 v182, v59, v120
    v_mul_f32 v183, v59, v124
    s_branch L_bp
L_nomlp:
    v_mov_b32 v168, 0
    v_mov_b32 v169, 0
    v_mov_b32 v170, 0
    v_mov_b32 v171, 0
    v_mov_b32 v172, 0
    v_mov_b32 v173, 0
    v_mov_b32 v174, 0
    v_mov_b32 v175, 0
    v_mov_b32 v176, 0
    v_mov_b32 v177, 0
    v_mov_b32 v178, 0
    v_mov_b32 v179, 0
    v_mov_b32 v180, 0
    v_mov_b32 v181, 0
    v_mov_b32 v182, 0
    v_mov_b32 v183, 0
L_bp:
    s_mov_b64 exec, 0xffff
    ds_write_b128 v23, v[168:171] offset:1536
    ds_write_b128 v23, v[172:175] offset:1552
    ds_write_b128 v23, v[176:179] offset:2048
    ds_write_b128 v23, v[180:183] offset:2064
    s_mov_b64 exec, 1
    ds_write_b64 v11, v[58:59] offset:1088
    ds_write_b32 v11, v12 offset:1112
    s_mov_b64 exec, -1
    s_cmp_ge_u32 s32, 4
    s_cbranch_scc1 L_w0end
    v_lshlrev_b32 v55, 16, v55
    v_mul_f32 v55, v59, v55
    s_lshl_b32 s45, s42, 8
    s_or_b32 s45, s45, s41
    s_lshl_b32 s34, s43, 16
    s_or_b32 s45, s45, s34
    s_lshl_b32 s34, s44, 24
    s_or_b32 s45, s45, s34
    v_mov_b32 v72, s45
    s_mov_b32 s96, 0x00010001
    s_mov_b32 s97, 0x00010001
    s_mov_b32 s48, 0
L_sp_44:
    ds_read_b32 v26, v11 offset:1120
    s_waitcnt lgkmcnt(0)
    v_readfirstlane_b32 s34, v26
    s_nop 0
    s_cmp_ge_u32 s34, 2
    s_cbranch_scc1 L_spd_45
    s_sleep 1
    s_add_u32 s48, s48, 1
    s_cmp_lt_u32 s48, 400000
    s_cbranch_scc1 L_sp_44
L_spd_45:
    global_load_dwordx4 v[64:67], v24, s[30:31] offset:0 sc1
    global_load_dwordx4 v[68:71], v25, s[30:31] offset:0 sc1
    s_mov_b32 s48, 0
L_sp_46:
    ds_read_b32 v26, v11 offset:1128
    s_waitcnt lgkmcnt(0)
    v_readfirstlane_b32 s34, v26
    s_nop 0
    s_cmp_ge_u32 s34, 2
    s_cbranch_scc1 L_spd_47
    s_sleep 1
    s_add_u32 s48, s48, 1
    s_cmp_lt_u32 s48, 400000
    s_cbranch_scc1 L_sp_46
L_spd_47:
    s_mov_b32 s48, 0
L_pl_48:
    s_waitcnt vmcnt(0)
    v_msad_u8 v26, v64, s41, 0
    v_msad_u8 v27, v68, s41, 0
    v_msad_u8 v26, v65, s42, v26
    v_msad_u8 v27, v69, s42, v27
    v_msad_u8 v26, v66, s43, v26
    v_msad_u8 v27, v70, s43, v27
    v_msad_u8 v26, v67, s44, v26
    v_msad_u8 v27, v71, s44, v27
    v_cmp_ne_u32 s[56:57], 0, v26
    v_cmp_ne_u32 s[58:59], 0, v27
    s_nop 0
    s_or_b64 s[50:51], s[56:57], s[58:59]
    s_cbranch_scc0 L_pld_49
    s_add_u32 s48, s48, 1
    s_cmp_ge_u32 s48, 400000
    s_cbranch_scc1 L_pld_49
    s_mov_b64 exec, s[56:57]
    s_cbranch_execz L_pls_50
    global_load_dwordx4 v[64:67], v24, s[30:31] offset:0 sc1
L_pls_50:
    s_mov_b64 exec, s[58:59]
    s_cbranch_execz L_pls_51
    global_load_dwordx4 v[68:71], v25, s[30:31] offset:0 sc1
L_pls_51:
    s_mov_b64 exec, -1
    s_branch L_pl_48
L_pld_49:
    v_add_f32 v64, v64, v68
    v_add_f32 v65, v65, v69
    v_add_f32 v66, v66, v70
    v_add_f32 v67, v67, v71
    v_permlane32_swap_b32 v64, v65
    s_nop 0
    v_permlane32_swap_b32 v66, v67
    v_add_f32 v64, v64, v65
    v_add_f32 v66, v66, v67
    s_nop 1
    v_permlane16_swap_b32 v64, v66
    v_add_f32 v64, v64, v66
    s_nop 1
    v_add_f32_dpp v64, v64, v64 quad_perm:[1,0,3,2] row_mask:0xf bank_mask:0xf
    s_nop 1
    v_add_f32_dpp v64, v64, v64 quad_perm:[2,3,0,1] row_mask:0xf bank_mask:0xf
    s_nop 1
    v_add_f32_dpp v64, v64, v64 row_half_mirror row_mask:0xf bank_mask:0xf
    s_nop 1
    v_add_f32_dpp v64, v64, v64 row_mirror row_mask:0xf bank_mask:0xf
    v_add_f32 v64, v64, v55
    v_cvt_pk_bf16_f32 v64, v64, v64
    s_mov_b64 exec, s[96:97]
    global_store_short v54, v64, s[26:27]
    s_cmp_lg_u32 s2, 0
    s_cbranch_scc1 L_w0end
    s_mov_b64 exec, 1
    global_store_dword v11, v72, s[30:31] offset:0
L_w0end:
    s_mov_b64 exec, -1
    s_endpgm
L_exit:
    s_endpgm
.section .rodata,"a"
.p2align 6
.amdhsa_kernel gated_mix__sliding_block_cached__dense_activation_gelu__decode_kernel
  .amdhsa_next_free_vgpr 384
  .amdhsa_next_free_sgpr 102
  .amdhsa_accum_offset 256
  .amdhsa_group_segment_fixed_size 0
  .amdhsa_kernarg_size 112
  .amdhsa_user_sgpr_count 2
  .amdhsa_user_sgpr_kernarg_segment_ptr 1
  .amdhsa_system_sgpr_workgroup_id_x 1
.end_amdhsa_kernel
```
